```python
import torch

def _softmax(x, axis=-1):
    return torch.softmax(x, dim=axis)
def _gelu(x):
    return torch.nn.functional.gelu(x, approximate="tanh")
def _silu(x):
    return torch.nn.functional.silu(x)
def _sigmoid(x):
    return torch.sigmoid(x)
def _layernorm(x, axis=-1, eps=1e-5):
    m = x.mean(dim=axis, keepdim=True)
    v = x.var(dim=axis, keepdim=True, unbiased=False)
    return (x - m) / torch.sqrt(v + eps)
def _scatter_add(tgt, idx, src, axis=0):
    return tgt.clone().index_add_(axis, idx, src)
def _segment_sum(src, seg, n):
    out = torch.zeros((n,) + src.shape[1:], dtype=src.dtype)
    return out.index_add_(0, seg, src)
def _pad(x, pw):
    flat = tuple(v for pair in reversed(pw) for v in pair)
    return torch.nn.functional.pad(x, flat)

kernel_name = 'standalone__gqa_block_cached__near_ridge'

def setup_inputs():

    _w = (lambda a: (lambda t: t.to(torch.bfloat16) if t.is_floating_point() else t)(torch.as_tensor(a)))
    B, Sq, D = 8, 64, 512
    Hq, Hkv, Sk, Dh = 32, 8, 64, 128
    assert Hq % Hkv == 0, (Hq, Hkv)
    return {
        "x": _w((lambda *s: torch.randn(*s, dtype=torch.bfloat16) * 0.8)(B, Sq, D)),
        "k_cache": _w((lambda *s: torch.randn(*s, dtype=torch.bfloat16) * 0.8)(B, Hkv, Sk, Dh)),
        "v_cache": _w((lambda *s: torch.randn(*s, dtype=torch.bfloat16) * 0.05)(B, Hkv, Sk, Dh)),
        "wq": _w((lambda *s: torch.randn(*s, dtype=torch.bfloat16) * 0.8)(D, Hq * Dh) * (D ** -0.5)),
        "wo": _w((lambda *s: torch.randn(*s, dtype=torch.bfloat16) * 0.05)(Hq * Dh, D) * ((Hq * Dh) ** -0.5)),
    }

def reference(x, k_cache, v_cache, wq, wo):
    B, Sq, D = x.shape
    Hq, Dh = 32, 128
    Hkv = k_cache.shape[1]
    rep = Hq // Hkv
    q = (lambda x, *d: x.permute(*d))((x @ wq).reshape(B, Sq, Hq, Dh), 0, 2, 1, 3)
    k = (lambda x, n, axis: torch.repeat_interleave(x, n, dim=axis))(k_cache, rep, axis=1)
    v = (lambda x, n, axis: torch.repeat_interleave(x, n, dim=axis))(v_cache, rep, axis=1)
    scores = torch.einsum("bhqd,bhkd->bhqk", q, k) * (Dh ** -0.5)
    p = _softmax(scores, axis=-1)
    o = torch.einsum("bhqk,bhkd->bhqd", p, v)
    return (lambda x, *d: x.permute(*d))(o, 0, 2, 1, 3).reshape(B, Sq, Hq * Dh) @ wo
```

```asm
; @launch grid=(256,1,1) block=(512,1,1) lds=163840
.amdgcn_target "amdgcn-amd-amdhsa--gfx950"
.text
.globl standalone__gqa_block_cached__near_ridge_kernel
.p2align 8
.type standalone__gqa_block_cached__near_ridge_kernel,@function
standalone__gqa_block_cached__near_ridge_kernel:
    s_cmp_ge_u32 s2, 256
    s_cbranch_scc1 L_end
    s_load_dwordx2 s[20:21], s[0:1], 0
    s_load_dwordx2 s[32:33], s[0:1], 24
    s_load_dwordx2 s[44:45], s[0:1], 56
    s_load_dwordx2 s[24:25], s[0:1], 8
    s_load_dwordx2 s[28:29], s[0:1], 16
    s_load_dwordx2 s[36:37], s[0:1], 32
    s_load_dwordx2 s[40:41], s[0:1], 40
    v_lshrrev_b32 v1, 6, v0
    v_and_b32 v0, 63, v0
    s_and_b32 s55, s2, 7
    v_readfirstlane_b32 s48, v1
    s_bfe_u32 s59, s2, 0x20003
    s_lshr_b32 s53, s2, 5
    s_lshl_b32 s54, s55, 2
    s_add_u32 s54, s54, s59
    s_mov_b32 s22, 0x80000
    s_mov_b32 s23, 0x20000
    s_mov_b32 s34, 0x400000
    s_mov_b32 s35, 0x20000
    s_mov_b32 s26, 0x100000
    s_mov_b32 s27, 0x20000
    s_mov_b32 s30, 0x100000
    s_mov_b32 s31, 0x20000
    s_mov_b32 s38, 0x400000
    s_mov_b32 s39, 0x20000
    s_mov_b32 s42, 0x80000
    s_mov_b32 s43, 0x20000
    s_mov_b32 s46, 0x10000000
    s_mov_b32 s47, 0x20000
    s_lshr_b32 s49, s55, 1
    s_and_b32 s51, s54, 7
    s_cmp_lt_u32 s48, 4
    s_cbranch_scc1 L_compute
    s_sub_u32 s63, s48, 4
    v_lshrrev_b32 v24, 3, v0
    v_and_b32 v25, 7, v0
    v_lshrrev_b32 v22, 1, v24
    v_xor_b32 v22, v25, v22
    v_lshlrev_b32 v26, 10, v24
    v_lshl_add_u32 v4, v22, 4, v26
    s_lshl_b32 s58, s53, 16
    s_lshl_b32 s59, s63, 14
    s_add_u32 s58, s58, s59
    v_add_u32 v4, s58, v4
    v_xor_b32 v5, 64, v4
    v_lshrrev_b32 v20, 4, v0
    v_and_b32 v21, 15, v0
    v_lshlrev_b32 v22, 2, v20
    v_xor_b32 v22, v21, v22
    v_lshlrev_b32 v23, 13, v20
    v_lshl_add_u32 v2, v22, 4, v23
    s_lshl_b32 s58, s54, 8
    s_lshl_b32 s59, s63, 17
    s_add_u32 s58, s58, s59
    v_add_u32 v2, s58, v2
    s_mov_b32 s64, 0
    s_mov_b32 s68, 0
    s_mov_b32 s65, 31744
    s_mov_b32 s69, 7168
    s_mov_b32 s66, 63488
    s_mov_b32 s70, 14336
    s_mov_b32 s67, 95232
    s_mov_b32 s71, 21504
    s_lshl_b32 s61, s63, 12
    s_lshl_b32 s62, s63, 11
    s_add_u32 s56, s55, s53
    s_waitcnt lgkmcnt(0)
    s_add_u32 s59, s56, 0
    s_and_b32 s59, s59, 7
    s_lshl_b32 s60, s59, 7
    s_add_u32 m0, s62, 98304
    v_add_u32 v14, s60, v4
    v_add_u32 v15, s60, v5
    s_lshl_b32 s60, s59, 19
    v_add_u32 v12, s60, v2
    buffer_load_dwordx4 v14, s[20:23], s68 offen offset:0 lds
    buffer_load_dwordx4 v15, s[20:23], s69 offen offset:1024 lds
    s_add_u32 m0, s61, 0
    s_nop 0
    buffer_load_dwordx4 v12, s[32:35], s64 offen offset:0 lds
    buffer_load_dwordx4 v12, s[32:35], s65 offen offset:1024 lds
    buffer_load_dwordx4 v12, s[32:35], s66 offen offset:2048 lds
    buffer_load_dwordx4 v12, s[32:35], s67 offen offset:3072 lds
    s_add_u32 s59, s56, 1
    s_and_b32 s59, s59, 7
    s_lshl_b32 s60, s59, 7
    s_add_u32 m0, s62, 106496
    v_add_u32 v14, s60, v4
    v_add_u32 v15, s60, v5
    s_lshl_b32 s60, s59, 19
    v_add_u32 v12, s60, v2
    buffer_load_dwordx4 v14, s[20:23], s68 offen offset:0 lds
    buffer_load_dwordx4 v15, s[20:23], s69 offen offset:1024 lds
    s_add_u32 m0, s61, 16384
    s_nop 0
    buffer_load_dwordx4 v12, s[32:35], s64 offen offset:0 lds
    buffer_load_dwordx4 v12, s[32:35], s65 offen offset:1024 lds
    buffer_load_dwordx4 v12, s[32:35], s66 offen offset:2048 lds
    buffer_load_dwordx4 v12, s[32:35], s67 offen offset:3072 lds
    v_xor_b32 v22, v21, v20
    v_lshlrev_b32 v23, 8, v20
    v_lshl_add_u32 v6, v22, 4, v23
    v_xor_b32 v7, 64, v6
    v_xor_b32 v8, 128, v6
    v_xor_b32 v9, 192, v6
    s_lshl_b32 s8, s53, 3
    s_add_u32 s8, s8, s55
    s_lshl_b32 s8, s8, 14
    s_add_u32 s8, s8, s61
    v_and_b32 v22, 2, v24
    v_lshlrev_b32 v22, 1, v22
    v_xor_b32 v22, v25, v22
    v_lshl_add_u32 v10, v22, 4, v26
    s_lshl_b32 s58, s51, 7
    s_lshl_b32 s59, s63, 15
    s_add_u32 s58, s58, s59
    v_add_u32 v10, s58, v10
    v_lshlrev_b32 v17, 4, v0
    v_and_b32 v18, 7, v0
    v_lshlrev_b32 v18, 2, v18
    s_xor_b32 s13, s53, s51
    s_and_b32 s13, s13, 1
    s_bfe_u32 s14, s53, 0x20001
    s_lshl_b32 s13, s13, 2
    s_lshl_b32 s9, s53, 3
    s_add_u32 s9, s9, s55
    s_and_b32 s9, s9, -2
    s_lshr_b32 s58, s13, 2
    s_add_u32 s9, s9, s58
    s_lshl_b32 s9, s9, 14
    s_add_u32 s9, s9, s61
    s_xor_b32 s10, s9, 16384
    s_lshl_b32 s11, s53, 2
    s_add_u32 s11, s11, s49
    s_lshl_b32 s11, s11, 5
    s_add_u32 s11, s11, s63
    s_lshl_b32 s11, s11, 11
    s_add_u32 s11, s11, 65536
    s_lshl_b32 s4, s53, 2
    s_add_u32 s4, s4, s49
    s_lshl_b32 s4, s4, 2
    s_add_u32 s4, s4, s63
    s_lshl_b32 s4, s4, 7
    s_add_u32 s4, s4, 4096
    s_add_u32 s59, s56, 2
    s_and_b32 s59, s59, 7
    s_lshl_b32 s60, s59, 7
    s_add_u32 m0, s62, 114688
    v_add_u32 v14, s60, v4
    v_add_u32 v15, s60, v5
    s_lshl_b32 s60, s59, 19
    v_add_u32 v12, s60, v2
    buffer_load_dwordx4 v14, s[20:23], s68 offen offset:0 lds
    buffer_load_dwordx4 v15, s[20:23], s69 offen offset:1024 lds
    s_add_u32 m0, s61, 32768
    s_nop 0
    buffer_load_dwordx4 v12, s[32:35], s64 offen offset:0 lds
    buffer_load_dwordx4 v12, s[32:35], s65 offen offset:1024 lds
    buffer_load_dwordx4 v12, s[32:35], s66 offen offset:2048 lds
    buffer_load_dwordx4 v12, s[32:35], s67 offen offset:3072 lds
    s_add_u32 s59, s56, 3
    s_and_b32 s59, s59, 7
    s_lshl_b32 s60, s59, 7
    s_add_u32 m0, s62, 122880
    v_add_u32 v14, s60, v4
    v_add_u32 v15, s60, v5
    s_lshl_b32 s60, s59, 19
    v_add_u32 v12, s60, v2
    s_waitcnt vmcnt(12)
    s_barrier
    buffer_load_dwordx4 v14, s[20:23], s68 offen offset:0 lds
    buffer_load_dwordx4 v15, s[20:23], s69 offen offset:1024 lds
    s_add_u32 m0, s61, 49152
    s_nop 0
    buffer_load_dwordx4 v12, s[32:35], s64 offen offset:0 lds
    buffer_load_dwordx4 v12, s[32:35], s65 offen offset:1024 lds
    buffer_load_dwordx4 v12, s[32:35], s66 offen offset:2048 lds
    buffer_load_dwordx4 v12, s[32:35], s67 offen offset:3072 lds
    s_add_u32 s59, s56, 4
    s_and_b32 s59, s59, 7
    s_lshl_b32 s60, s59, 7
    s_add_u32 m0, s62, 131072
    v_add_u32 v14, s60, v4
    v_add_u32 v15, s60, v5
    s_lshl_b32 s60, s59, 19
    v_add_u32 v12, s60, v2
    s_waitcnt vmcnt(12)
    s_barrier
    buffer_load_dwordx4 v14, s[20:23], s68 offen offset:0 lds
    buffer_load_dwordx4 v15, s[20:23], s69 offen offset:1024 lds
    s_add_u32 m0, s61, 65536
    s_nop 0
    buffer_load_dwordx4 v12, s[32:35], s64 offen offset:0 lds
    buffer_load_dwordx4 v12, s[32:35], s65 offen offset:1024 lds
    buffer_load_dwordx4 v12, s[32:35], s66 offen offset:2048 lds
    buffer_load_dwordx4 v12, s[32:35], s67 offen offset:3072 lds
    s_lshl_b32 s58, s53, 8
    s_load_dword s57, s[44:45], s58
    s_add_u32 s59, s56, 5
    s_and_b32 s59, s59, 7
    s_lshl_b32 s60, s59, 7
    s_add_u32 m0, s62, 139264
    v_add_u32 v14, s60, v4
    v_add_u32 v15, s60, v5
    s_lshl_b32 s60, s59, 19
    v_add_u32 v12, s60, v2
    s_waitcnt vmcnt(12)
    s_barrier
    buffer_load_dwordx4 v14, s[20:23], s68 offen offset:0 lds
    buffer_load_dwordx4 v15, s[20:23], s69 offen offset:1024 lds
    s_add_u32 m0, s61, 81920
    s_nop 0
    buffer_load_dwordx4 v12, s[32:35], s64 offen offset:0 lds
    buffer_load_dwordx4 v12, s[32:35], s65 offen offset:1024 lds
    buffer_load_dwordx4 v12, s[32:35], s66 offen offset:2048 lds
    buffer_load_dwordx4 v12, s[32:35], s67 offen offset:3072 lds
    s_add_u32 m0, s61, 147456
    s_waitcnt vmcnt(12)
    s_barrier
    buffer_load_dwordx4 v6, s[24:27], s8 offen offset:0 lds
    buffer_load_dwordx4 v7, s[24:27], s8 offen offset:1024 lds
    buffer_load_dwordx4 v8, s[24:27], s8 offen offset:2048 lds
    buffer_load_dwordx4 v9, s[24:27], s8 offen offset:3072 lds
    s_add_u32 s59, s56, 6
    s_and_b32 s59, s59, 7
    s_lshl_b32 s60, s59, 7
    s_add_u32 m0, s62, 98304
    v_add_u32 v14, s60, v4
    v_add_u32 v15, s60, v5
    s_lshl_b32 s60, s59, 19
    v_add_u32 v12, s60, v2
    buffer_load_dwordx4 v14, s[20:23], s68 offen offset:0 lds
    buffer_load_dwordx4 v15, s[20:23], s69 offen offset:1024 lds
    s_add_u32 m0, s61, 0
    s_nop 0
    buffer_load_dwordx4 v12, s[32:35], s64 offen offset:0 lds
    buffer_load_dwordx4 v12, s[32:35], s65 offen offset:1024 lds
    buffer_load_dwordx4 v12, s[32:35], s66 offen offset:2048 lds
    buffer_load_dwordx4 v12, s[32:35], s67 offen offset:3072 lds
    s_add_u32 s59, s56, 7
    s_and_b32 s59, s59, 7
    s_lshl_b32 s60, s59, 7
    s_add_u32 m0, s62, 106496
    v_add_u32 v14, s60, v4
    v_add_u32 v15, s60, v5
    s_lshl_b32 s60, s59, 19
    v_add_u32 v12, s60, v2
    s_waitcnt vmcnt(16)
    s_barrier
    buffer_load_dwordx4 v14, s[20:23], s68 offen offset:0 lds
    buffer_load_dwordx4 v15, s[20:23], s69 offen offset:1024 lds
    s_add_u32 m0, s61, 16384
    s_nop 0
    buffer_load_dwordx4 v12, s[32:35], s64 offen offset:0 lds
    buffer_load_dwordx4 v12, s[32:35], s65 offen offset:1024 lds
    buffer_load_dwordx4 v12, s[32:35], s66 offen offset:2048 lds
    buffer_load_dwordx4 v12, s[32:35], s67 offen offset:3072 lds
    s_add_u32 m0, s61, 32768
    s_waitcnt vmcnt(16)
    s_barrier
    buffer_load_dwordx4 v6, s[28:31], s9 offen offset:0 lds
    buffer_load_dwordx4 v7, s[28:31], s9 offen offset:1024 lds
    buffer_load_dwordx4 v8, s[28:31], s9 offen offset:2048 lds
    buffer_load_dwordx4 v9, s[28:31], s9 offen offset:3072 lds
    s_waitcnt lgkmcnt(0)
    s_mul_i32 s57, s57, 0x9E3779B1
    s_add_u32 s57, s57, 0x7F4A7C15
    s_add_u32 s58, s14, 0
    s_and_b32 s58, s58, 3
    s_or_b32 s58, s58, s13
    s_lshl_b32 s58, s58, 13
    v_add_u32 v48, s58, v17
    s_add_u32 s58, s14, 1
    s_and_b32 s58, s58, 3
    s_or_b32 s58, s58, s13
    s_lshl_b32 s58, s58, 13
    v_add_u32 v49, s58, v17
    s_add_u32 s58, s14, 2
    s_and_b32 s58, s58, 3
    s_or_b32 s58, s58, s13
    s_lshl_b32 s58, s58, 13
    v_add_u32 v50, s58, v17
    s_add_u32 s58, s14, 3
    s_and_b32 s58, s58, 3
    s_or_b32 s58, s58, s13
    s_lshl_b32 s58, s58, 13
    v_add_u32 v51, s58, v17
    s_add_u32 s58, s14, 0
    s_and_b32 s58, s58, 3
    s_or_b32 s58, s58, s13
    s_xor_b32 s58, s58, 4
    s_lshl_b32 s58, s58, 13
    v_add_u32 v52, s58, v17
    s_add_u32 s58, s14, 1
    s_and_b32 s58, s58, 3
    s_or_b32 s58, s58, s13
    s_xor_b32 s58, s58, 4
    s_lshl_b32 s58, s58, 13
    v_add_u32 v53, s58, v17
    s_add_u32 s58, s14, 2
    s_and_b32 s58, s58, 3
    s_or_b32 s58, s58, s13
    s_xor_b32 s58, s58, 4
    s_lshl_b32 s58, s58, 13
    v_add_u32 v54, s58, v17
    s_add_u32 s58, s14, 3
    s_and_b32 s58, s58, 3
    s_or_b32 s58, s58, s13
    s_xor_b32 s58, s58, 4
    s_lshl_b32 s58, s58, 13
    v_add_u32 v55, s58, v17
    s_lshl_b32 s16, s53, 3
    s_add_u32 s16, s16, s51
    s_lshl_b32 s16, s16, 16
    s_lshl_b32 s58, s63, 10
    s_add_u32 s16, s16, s58
    s_add_u32 s16, s16, 4194304
    s_add_u32 s58, s49, 1
    s_and_b32 s58, s58, 3
    s_lshl_b32 s59, s49, 2
    s_add_u32 s58, s58, s59
    s_lshl_b32 s58, s58, 12
    s_add_u32 s6, s58, s16
    s_add_u32 s58, s49, 2
    s_and_b32 s58, s58, 3
    s_lshl_b32 s59, s49, 2
    s_add_u32 s58, s58, s59
    s_lshl_b32 s58, s58, 12
    s_add_u32 s7, s58, s16
    s_add_u32 s58, s49, 3
    s_and_b32 s58, s58, 3
    s_lshl_b32 s59, s49, 2
    s_add_u32 s58, s58, s59
    s_lshl_b32 s58, s58, 12
    s_add_u32 s12, s58, s16
    s_lshl_b32 s15, s53, 16
    s_and_b32 s58, s63, 1
    s_lshl_b32 s58, s58, 15
    s_add_u32 s15, s15, s58
    s_lshl_b32 s58, s51, 7
    s_add_u32 s15, s15, s58
    s_lshr_b32 s58, s63, 1
    s_lshl_b32 s58, s58, 6
    s_add_u32 s15, s15, s58
    s_lshl_b32 s58, s49, 4
    s_add_u32 s15, s15, s58
    s_lshl_b32 s15, s53, 16
    s_lshl_b32 s58, s49, 14
    s_add_u32 s15, s15, s58
    s_lshl_b32 s58, s51, 7
    s_add_u32 s15, s15, s58
    s_lshl_b32 s58, s63, 5
    s_add_u32 s15, s15, s58
    v_and_b32 v20, 15, v0
    v_lshrrev_b32 v21, 4, v0
    v_lshlrev_b32 v21, 3, v21
    v_lshl_add_u32 v27, v20, 10, v21
    v_mov_b32 v28, 0xfff
    s_lshl_b32 s58, s63, 10
    s_add_u32 s58, s58, 147456
    v_add_u32 v29, s58, v17
    s_and_b32 s58, s57, 0xfff
    v_mov_b32 v56, s58
    s_bfe_u32 s58, s57, 0xc000c
    v_mov_b32 v57, s58
    s_lshr_b32 s58, s57, 24
    s_or_b32 s58, s58, 0xa00
    v_mov_b32 v58, s58
    s_mul_i32 s58, s57, 0x85EBCA6B
    s_lshr_b32 s58, s58, 20
    v_mov_b32 v59, s58
    s_add_u32 s59, s14, 0
    s_and_b32 s59, s59, 3
    s_or_b32 s59, s59, s13
    s_lshl_b32 s60, s49, 3
    s_add_u32 s59, s59, s60
    s_lshl_b32 s59, s59, 17
    s_add_u32 m0, s61, 49152
    v_add_u32 v16, s59, v10
    s_waitcnt vmcnt(10)
    s_barrier
    buffer_load_dwordx4 v16, s[36:39], s68 offen offset:0 lds
    buffer_load_dwordx4 v16, s[36:39], s69 offen offset:1024 lds
    buffer_load_dwordx4 v16, s[36:39], s70 offen offset:2048 lds
    buffer_load_dwordx4 v16, s[36:39], s71 offen offset:3072 lds
    s_add_u32 s59, s14, 1
    s_and_b32 s59, s59, 3
    s_or_b32 s59, s59, s13
    s_lshl_b32 s60, s49, 3
    s_add_u32 s59, s59, s60
    s_lshl_b32 s59, s59, 17
    s_add_u32 m0, s61, 65536
    v_add_u32 v16, s59, v10
    v_and_b32 v30, 3, v0
    v_lshlrev_b32 v30, 6, v30
    v_add_u32 v30, 135168, v30
    s_mov_b32 s60, 524288
    s_waitcnt vmcnt(8)
    s_barrier
L_qgate:
    ds_read_b32 v21, v30
    s_sub_u32 s60, s60, 1
    s_waitcnt lgkmcnt(0)
    v_cmp_eq_u32 vcc, 0, v21
    s_cmp_eq_u32 s60, 0
    s_cbranch_scc1 L_qgate_done
    s_cbranch_vccnz L_qgate
L_qgate_done:
    buffer_load_dwordx4 v16, s[36:39], s68 offen offset:0 lds
    buffer_load_dwordx4 v16, s[36:39], s69 offen offset:1024 lds
    buffer_load_dwordx4 v16, s[36:39], s70 offen offset:2048 lds
    buffer_load_dwordx4 v16, s[36:39], s71 offen offset:3072 lds
    s_add_u32 s59, s14, 2
    s_and_b32 s59, s59, 3
    s_or_b32 s59, s59, s13
    s_lshl_b32 s60, s49, 3
    s_add_u32 s59, s59, s60
    s_lshl_b32 s59, s59, 17
    s_add_u32 m0, s61, 81920
    v_add_u32 v16, s59, v10
    buffer_load_dwordx4 v16, s[36:39], s68 offen offset:0 lds
    buffer_load_dwordx4 v16, s[36:39], s69 offen offset:1024 lds
    buffer_load_dwordx4 v16, s[36:39], s70 offen offset:2048 lds
    buffer_load_dwordx4 v16, s[36:39], s71 offen offset:3072 lds
    s_add_u32 s59, s14, 3
    s_and_b32 s59, s59, 3
    s_or_b32 s59, s59, s13
    s_lshl_b32 s60, s49, 3
    s_add_u32 s59, s59, s60
    s_lshl_b32 s59, s59, 17
    s_add_u32 m0, s61, 114688
    v_add_u32 v16, s59, v10
    buffer_load_dwordx4 v16, s[36:39], s68 offen offset:0 lds
    buffer_load_dwordx4 v16, s[36:39], s69 offen offset:1024 lds
    buffer_load_dwordx4 v16, s[36:39], s70 offen offset:2048 lds
    buffer_load_dwordx4 v16, s[36:39], s71 offen offset:3072 lds
    s_add_u32 m0, s61, 147456
    s_waitcnt vmcnt(12)
    s_barrier
    buffer_load_dwordx4 v6, s[28:31], s10 offen offset:0 lds
    buffer_load_dwordx4 v7, s[28:31], s10 offen offset:1024 lds
    buffer_load_dwordx4 v8, s[28:31], s10 offen offset:2048 lds
    buffer_load_dwordx4 v9, s[28:31], s10 offen offset:3072 lds
    s_add_u32 s59, s14, 0
    s_and_b32 s59, s59, 3
    s_or_b32 s59, s59, s13
    s_xor_b32 s59, s59, 4
    s_lshl_b32 s60, s49, 3
    s_add_u32 s59, s59, s60
    s_lshl_b32 s59, s59, 17
    s_add_u32 m0, s61, 131072
    v_add_u32 v16, s59, v10
    s_waitcnt vmcnt(12)
    s_barrier
    buffer_load_dwordx4 v16, s[36:39], s68 offen offset:0 lds
    buffer_load_dwordx4 v16, s[36:39], s69 offen offset:1024 lds
    buffer_load_dwordx4 v16, s[36:39], s70 offen offset:2048 lds
    buffer_load_dwordx4 v16, s[36:39], s71 offen offset:3072 lds
    s_add_u32 s59, s14, 1
    s_and_b32 s59, s59, 3
    s_or_b32 s59, s59, s13
    s_xor_b32 s59, s59, 4
    s_lshl_b32 s60, s49, 3
    s_add_u32 s59, s59, s60
    s_lshl_b32 s59, s59, 17
    s_add_u32 m0, s61, 0
    v_add_u32 v16, s59, v10
    s_waitcnt vmcnt(12)
    s_barrier
    buffer_load_dwordx4 v16, s[36:39], s68 offen offset:0 lds
    buffer_load_dwordx4 v16, s[36:39], s69 offen offset:1024 lds
    buffer_load_dwordx4 v16, s[36:39], s70 offen offset:2048 lds
    buffer_load_dwordx4 v16, s[36:39], s71 offen offset:3072 lds
    s_add_u32 s59, s14, 2
    s_and_b32 s59, s59, 3
    s_or_b32 s59, s59, s13
    s_xor_b32 s59, s59, 4
    s_lshl_b32 s60, s49, 3
    s_add_u32 s59, s59, s60
    s_lshl_b32 s59, s59, 17
    s_add_u32 m0, s61, 16384
    v_add_u32 v16, s59, v10
    s_waitcnt vmcnt(12)
    s_barrier
    buffer_load_dwordx4 v16, s[36:39], s68 offen offset:0 lds
    buffer_load_dwordx4 v16, s[36:39], s69 offen offset:1024 lds
    buffer_load_dwordx4 v16, s[36:39], s70 offen offset:2048 lds
    buffer_load_dwordx4 v16, s[36:39], s71 offen offset:3072 lds
    s_add_u32 s59, s14, 3
    s_and_b32 s59, s59, 3
    s_or_b32 s59, s59, s13
    s_xor_b32 s59, s59, 4
    s_lshl_b32 s60, s49, 3
    s_add_u32 s59, s59, s60
    s_lshl_b32 s59, s59, 17
    s_add_u32 m0, s61, 98304
    v_add_u32 v16, s59, v10
    buffer_load_dwordx4 v16, s[36:39], s68 offen offset:0 lds
    buffer_load_dwordx4 v16, s[36:39], s69 offen offset:1024 lds
    buffer_load_dwordx4 v16, s[36:39], s70 offen offset:2048 lds
    buffer_load_dwordx4 v16, s[36:39], s71 offen offset:3072 lds
    s_waitcnt vmcnt(12)
    s_barrier
    buffer_load_dword v19, v18, s[44:47], s4 offen sc1
    s_waitcnt vmcnt(9)
    s_barrier
    s_waitcnt vmcnt(0)
    s_barrier
    s_mov_b32 s60, 524288
    v_cmp_ne_u32 vcc, s57, v19
    s_lshl_b32 s61, s63, 11
    s_cbranch_vccz L_poll1_done
L_poll1:
    buffer_load_dword v19, v18, s[44:47], s4 offen sc1
    s_sub_u32 s60, s60, 1
    s_waitcnt vmcnt(0)
    v_cmp_ne_u32 vcc, s57, v19
    s_cmp_eq_u32 s60, 0
    s_cbranch_scc1 L_poll1_done
    s_cbranch_vccnz L_poll1
L_poll1_done:
    s_add_u32 m0, s61, 32768
    s_nop 0
    buffer_load_dwordx4 v48, s[44:47], s11 offen sc1 lds
    buffer_load_dwordx4 v48, s[44:47], s11 offen offset:1024 sc1 lds
    s_add_u32 m0, s61, 40960
    s_nop 0
    buffer_load_dwordx4 v49, s[44:47], s11 offen sc1 lds
    buffer_load_dwordx4 v49, s[44:47], s11 offen offset:1024 sc1 lds
    s_add_u32 m0, s61, 49152
    s_nop 0
    buffer_load_dwordx4 v50, s[44:47], s11 offen sc1 lds
    buffer_load_dwordx4 v50, s[44:47], s11 offen offset:1024 sc1 lds
    s_add_u32 m0, s61, 57344
    s_nop 0
    buffer_load_dwordx4 v51, s[44:47], s11 offen sc1 lds
    buffer_load_dwordx4 v51, s[44:47], s11 offen offset:1024 sc1 lds
    s_add_u32 m0, s61, 65536
    s_nop 0
    buffer_load_dwordx4 v52, s[44:47], s11 offen sc1 lds
    buffer_load_dwordx4 v52, s[44:47], s11 offen offset:1024 sc1 lds
    s_add_u32 m0, s61, 73728
    s_nop 0
    buffer_load_dwordx4 v53, s[44:47], s11 offen sc1 lds
    buffer_load_dwordx4 v53, s[44:47], s11 offen offset:1024 sc1 lds
    s_add_u32 m0, s61, 81920
    s_nop 0
    buffer_load_dwordx4 v54, s[44:47], s11 offen sc1 lds
    buffer_load_dwordx4 v54, s[44:47], s11 offen offset:1024 sc1 lds
    s_add_u32 m0, s61, 90112
    s_nop 0
    buffer_load_dwordx4 v55, s[44:47], s11 offen sc1 lds
    buffer_load_dwordx4 v55, s[44:47], s11 offen offset:1024 sc1 lds
    s_waitcnt vmcnt(14)
    s_barrier
    s_waitcnt vmcnt(12)
    s_barrier
    s_waitcnt vmcnt(10)
    s_barrier
    s_waitcnt vmcnt(8)
    s_barrier
    s_waitcnt vmcnt(6)
    s_barrier
    s_waitcnt vmcnt(4)
    s_barrier
    s_waitcnt vmcnt(2)
    s_barrier
    s_waitcnt vmcnt(0)
    s_barrier
    s_barrier
    s_barrier
    ds_read_b128 v[44:47], v29
    s_mov_b32 s60, 524288
L_poll2:
    buffer_load_dwordx4 v[32:35], v17, s[44:47], s6 offen sc1
    buffer_load_dwordx4 v[36:39], v17, s[44:47], s7 offen sc1
    buffer_load_dwordx4 v[40:43], v17, s[44:47], s12 offen sc1
    s_sub_u32 s60, s60, 1
    s_waitcnt vmcnt(0)
    v_xor_b32 v32, v56, v32
    v_xor_b32 v33, v57, v33
    v_xor_b32 v34, v58, v34
    v_xor_b32 v35, v59, v35
    v_xor_b32 v36, v56, v36
    v_xor_b32 v37, v57, v37
    v_xor_b32 v38, v58, v38
    v_xor_b32 v39, v59, v39
    v_xor_b32 v40, v56, v40
    v_xor_b32 v41, v57, v41
    v_xor_b32 v42, v58, v42
    v_xor_b32 v43, v59, v43
    v_or3_b32 v20, v32, v33, v34
    v_or3_b32 v21, v36, v37, v38
    v_or3_b32 v22, v40, v41, v42
    v_or3_b32 v23, v35, v39, v43
    v_or3_b32 v20, v20, v21, v22
    v_or_b32 v20, v20, v23
    v_and_b32 v20, v28, v20
    v_cmp_ne_u32 vcc, 0, v20
    s_cmp_eq_u32 s60, 0
    s_cbranch_scc1 L_poll2_done
    s_cbranch_vccnz L_poll2
L_poll2_done:
    s_waitcnt lgkmcnt(0)
    v_pk_add_f32 v[44:45], v[44:45], v[32:33]
    v_pk_add_f32 v[46:47], v[46:47], v[34:35]
    v_pk_add_f32 v[36:37], v[36:37], v[40:41]
    v_pk_add_f32 v[38:39], v[38:39], v[42:43]
    v_pk_add_f32 v[44:45], v[44:45], v[36:37]
    v_pk_add_f32 v[46:47], v[46:47], v[38:39]
    v_cvt_pk_bf16_f32 v20, v44, v45
    v_cvt_pk_bf16_f32 v21, v46, v47
    buffer_store_dwordx2 v[20:21], v27, s[40:43], s15 offen
    s_or_b32 s58, s49, s51
    s_or_b32 s58, s58, s63
    s_cmp_lg_u32 s58, 0
    s_cbranch_scc1 L_end
    s_lshl_b32 s58, s53, 8
    v_mov_b32 v1, s57
    v_mov_b32 v5, 0
    s_mov_b64 exec, 1
    buffer_store_dword v1, v5, s[44:47], s58 offen
    s_endpgm
L_compute:
    v_and_b32 v1, 31, v0
    v_lshrrev_b32 v2, 5, v0
    v_bfe_u32 v3, v0, 2, 2
    v_and_b32 v4, 1, v0
    v_bfe_u32 v5, v0, 1, 1
    v_bfe_u32 v6, v0, 4, 1
    v_lshlrev_b32 v228, 4, v0
    s_and_b32 s61, s48, 1
    s_lshr_b32 s62, s48, 1
    s_waitcnt lgkmcnt(0)
    v_lshl_add_u32 v7, v2, 3, v3
    v_lshlrev_b32 v8, 5, v6
    v_lshl_add_u32 v8, v4, 4, v8
    v_lshl_add_u32 v8, v5, 3, v8
    v_lshl_add_u32 v8, v7, 8, v8
    s_lshl_b32 s58, s62, 1
    v_xor_b32 v9, s58, v3
    v_lshl_add_u32 v208, v9, 6, v8
    v_xor_b32 v209, 64, v208
    v_add_u32 v210, 0x10000, v208
    v_add_u32 v211, 0x10000, v209
    v_bfe_u32 v8, v1, 1, 3
    v_xor_b32 v8, v8, v2
    v_lshlrev_b32 v9, 7, v1
    v_lshl_add_u32 v8, v8, 4, v9
    s_lshl_b32 s58, s61, 12
    s_add_u32 s58, s58, 98304
    v_add_u32 v212, s58, v8
    v_xor_b32 v213, 32, v212
    v_xor_b32 v214, 64, v212
    v_xor_b32 v215, 96, v212
    v_lshrrev_b32 v8, 1, v3
    v_xor_b32 v8, s62, v8
    v_lshlrev_b32 v8, 6, v8
    v_lshlrev_b32 v9, 1, v6
    v_add_u32 v9, v9, v5
    v_lshl_add_u32 v8, v9, 4, v8
    v_lshl_add_u32 v8, v4, 3, v8
    v_lshl_add_u32 v224, v7, 7, v8
    v_add_u32 v225, 0x10000, v224
    v_add_u32 v226, 0x20000, v224
    v_and_b32 v8, 15, v1
    v_xor_b32 v8, v8, v2
    v_lshlrev_b32 v9, 8, v1
    v_lshl_add_u32 v7, v8, 4, v9
    s_lshl_b32 s58, s61, 13
    s_add_u32 s58, s58, 32768
    v_add_u32 v216, s58, v7
    v_xor_b32 v217, 32, v216
    v_xor_b32 v218, 64, v216
    v_xor_b32 v219, 96, v216
    v_xor_b32 v220, 128, v216
    v_xor_b32 v221, 160, v216
    v_xor_b32 v222, 192, v216
    v_xor_b32 v223, 224, v216
    s_lshl_b32 s58, s62, 7
    v_xor_b32 v7, s58, v7
    s_lshl_b32 s58, s62, 13
    s_add_u32 s58, s58, 147456
    v_add_u32 v7, s58, v7
    v_xor_b32 v8, 0, v7
    v_xor_b32 v9, 32, v7
    v_xor_b32 v10, 64, v7
    v_xor_b32 v11, 96, v7
    v_xor_b32 v12, 128, v7
    v_xor_b32 v13, 160, v7
    v_xor_b32 v14, 192, v7
    v_xor_b32 v15, 224, v7
    s_mul_i32 s58, s61, 6144
    s_add_u32 s58, s58, 32768
    v_add_u32 v236, s58, v228
    v_xor_b32 v237, 0x800, v236
    s_lshl_b32 s58, s48, 12
    v_add_u32 v229, s58, v228
    v_xor_b32 v230, 0x2000, v229
    v_xor_b32 v234, 0x1000, v229
    v_add_u32 v233, 114688, v229
    v_add_u32 v234, 114688, v234
    s_lshl_b32 s58, s48, 6
    s_add_u32 s58, s58, 135168
    v_mov_b32 v238, s58
    v_xor_b32 v239, 0x80, v238
    v_mov_b32 v240, 0
    v_mov_b32 v241, 0
    v_mov_b32 v242, 1
    s_lshl_b32 s58, s48, 8
    s_add_u32 s58, s58, 131072
    v_lshlrev_b32 v7, 3, v1
    v_add_u32 v231, s58, v7
    v_xor_b32 v232, 0x200, v231
    v_and_b32 v7, 15, v1
    v_lshlrev_b32 v7, 4, v7
    v_lshl_add_u32 v7, v2, 8, v7
    s_lshl_b32 s58, s62, 11
    v_add_u32 v7, s58, v7
    v_add_u32 v235, 147456, v7
    v_lshrrev_b32 v6, 4, v1
    v_lshl_add_u32 v244, v6, 14, v7
    s_lshl_b32 s58, s61, 1
    v_add_u32 v6, s58, v6
    v_cmp_eq_u32 s[18:19], s49, v6
    v_mov_b32 v6, 0x7ffffff0
    s_nop 0
    v_cndmask_b32 v244, v244, v6, s[18:19]
    s_lshl_b32 s4, s53, 2
    s_add_u32 s4, s4, s49
    s_lshl_b32 s4, s4, 2
    s_add_u32 s4, s4, s48
    s_lshl_b32 s4, s4, 7
    s_add_u32 s4, s4, 4096
    s_lshl_b32 s58, s51, 2
    s_add_u32 s4, s4, s58
    s_lshl_b32 s5, s53, 5
    s_add_u32 s5, s5, s54
    s_lshl_b32 s5, s5, 2
    s_add_u32 s5, s5, s48
    s_lshl_b32 s5, s5, 11
    s_add_u32 s5, s5, 65536
    s_lshl_b32 s72, s53, 3
    s_add_u32 s72, s72, s51
    s_lshl_b32 s72, s72, 16
    s_lshl_b32 s58, s61, 15
    s_add_u32 s72, s72, s58
    s_lshl_b32 s58, s49, 12
    s_add_u32 s72, s72, s58
    s_add_u32 s72, s72, 4194304
    s_mov_b32 s64, 0x3e0293ee
    s_mov_b32 s65, 0x3e0293ee
    s_barrier
    ds_read_b128 v[80:83], v212 offset:0
    ds_read_b64_tr_b16 v[48:49], v208 offset:0
    ds_read_b64_tr_b16 v[50:51], v208 offset:1024
    ds_read_b64_tr_b16 v[52:53], v209 offset:0
    ds_read_b64_tr_b16 v[54:55], v209 offset:1024
    ds_read_b128 v[84:87], v213 offset:0
    ds_read_b64_tr_b16 v[56:57], v208 offset:4096
    ds_read_b64_tr_b16 v[58:59], v208 offset:5120
    ds_read_b64_tr_b16 v[60:61], v209 offset:4096
    ds_read_b64_tr_b16 v[62:63], v209 offset:5120
    ds_read_b128 v[88:91], v214 offset:0
    ds_read_b64_tr_b16 v[64:65], v208 offset:8192
    s_waitcnt lgkmcnt(9)
    v_mfma_f32_32x32x16_bf16 v[16:31], v[48:51], v[80:83], 0
    ds_read_b64_tr_b16 v[66:67], v208 offset:9216
    ds_read_b64_tr_b16 v[68:69], v209 offset:8192
    ds_read_b64_tr_b16 v[70:71], v209 offset:9216
    s_waitcnt lgkmcnt(10)
    v_mfma_f32_32x32x16_bf16 v[32:47], v[52:55], v[80:83], 0
    ds_read_b128 v[92:95], v215 offset:0
    ds_read_b64_tr_b16 v[72:73], v208 offset:12288
    ds_read_b64_tr_b16 v[74:75], v208 offset:13312
    s_waitcnt lgkmcnt(10)
    v_mfma_f32_32x32x16_bf16 v[16:31], v[56:59], v[84:87], v[16:31]
    s_lshl_b32 s58, s53, 8
    s_load_dword s57, s[44:45], s58
    ds_read_b64_tr_b16 v[76:77], v209 offset:12288
    ds_read_b64_tr_b16 v[78:79], v209 offset:13312
    s_waitcnt lgkmcnt(10)
    v_mfma_f32_32x32x16_bf16 v[32:47], v[60:63], v[84:87], v[32:47]
    s_barrier
    ds_read_b128 v[80:83], v212 offset:8192
    ds_read_b64_tr_b16 v[48:49], v208 offset:16384
    ds_read_b64_tr_b16 v[50:51], v208 offset:17408
    s_waitcnt lgkmcnt(10)
    v_mfma_f32_32x32x16_bf16 v[16:31], v[64:67], v[88:91], v[16:31]
    ds_read_b64_tr_b16 v[52:53], v209 offset:16384
    ds_read_b64_tr_b16 v[54:55], v209 offset:17408
    s_waitcnt lgkmcnt(10)
    v_mfma_f32_32x32x16_bf16 v[32:47], v[68:71], v[88:91], v[32:47]
    ds_read_b128 v[84:87], v213 offset:8192
    ds_read_b64_tr_b16 v[56:57], v208 offset:20480
    ds_read_b64_tr_b16 v[58:59], v208 offset:21504
    s_waitcnt lgkmcnt(10)
    v_mfma_f32_32x32x16_bf16 v[16:31], v[72:75], v[92:95], v[16:31]
    ds_read_b64_tr_b16 v[60:61], v209 offset:20480
    ds_read_b64_tr_b16 v[62:63], v209 offset:21504
    s_waitcnt lgkmcnt(10)
    v_mfma_f32_32x32x16_bf16 v[32:47], v[76:79], v[92:95], v[32:47]
    ds_read_b128 v[88:91], v214 offset:8192
    ds_read_b64_tr_b16 v[64:65], v208 offset:24576
    ds_read_b64_tr_b16 v[66:67], v208 offset:25600
    s_waitcnt lgkmcnt(10)
    v_mfma_f32_32x32x16_bf16 v[16:31], v[48:51], v[80:83], v[16:31]
    ds_read_b64_tr_b16 v[68:69], v209 offset:24576
    ds_read_b64_tr_b16 v[70:71], v209 offset:25600
    s_waitcnt lgkmcnt(10)
    v_mfma_f32_32x32x16_bf16 v[32:47], v[52:55], v[80:83], v[32:47]
    ds_read_b128 v[92:95], v215 offset:8192
    ds_read_b64_tr_b16 v[72:73], v208 offset:28672
    ds_read_b64_tr_b16 v[74:75], v208 offset:29696
    s_waitcnt lgkmcnt(10)
    v_mfma_f32_32x32x16_bf16 v[16:31], v[56:59], v[84:87], v[16:31]
    ds_read_b64_tr_b16 v[76:77], v209 offset:28672
    ds_read_b64_tr_b16 v[78:79], v209 offset:29696
    s_waitcnt lgkmcnt(10)
    v_mfma_f32_32x32x16_bf16 v[32:47], v[60:63], v[84:87], v[32:47]
    s_barrier
    ds_read_b128 v[80:83], v212 offset:16384
    ds_read_b64_tr_b16 v[48:49], v208 offset:32768
    ds_read_b64_tr_b16 v[50:51], v208 offset:33792
    s_waitcnt lgkmcnt(10)
    v_mfma_f32_32x32x16_bf16 v[16:31], v[64:67], v[88:91], v[16:31]
    ds_read_b64_tr_b16 v[52:53], v209 offset:32768
    ds_read_b64_tr_b16 v[54:55], v209 offset:33792
    s_waitcnt lgkmcnt(10)
    v_mfma_f32_32x32x16_bf16 v[32:47], v[68:71], v[88:91], v[32:47]
    ds_read_b128 v[84:87], v213 offset:16384
    ds_read_b64_tr_b16 v[56:57], v208 offset:36864
    ds_read_b64_tr_b16 v[58:59], v208 offset:37888
    s_waitcnt lgkmcnt(10)
    v_mfma_f32_32x32x16_bf16 v[16:31], v[72:75], v[92:95], v[16:31]
    ds_read_b64_tr_b16 v[60:61], v209 offset:36864
    ds_read_b64_tr_b16 v[62:63], v209 offset:37888
    s_waitcnt lgkmcnt(10)
    v_mfma_f32_32x32x16_bf16 v[32:47], v[76:79], v[92:95], v[32:47]
    ds_read_b128 v[88:91], v214 offset:16384
    ds_read_b64_tr_b16 v[64:65], v208 offset:40960
    ds_read_b64_tr_b16 v[66:67], v208 offset:41984
    s_waitcnt lgkmcnt(10)
    v_mfma_f32_32x32x16_bf16 v[16:31], v[48:51], v[80:83], v[16:31]
    ds_read_b64_tr_b16 v[68:69], v209 offset:40960
    ds_read_b64_tr_b16 v[70:71], v209 offset:41984
    s_waitcnt lgkmcnt(10)
    v_mfma_f32_32x32x16_bf16 v[32:47], v[52:55], v[80:83], v[32:47]
    ds_read_b128 v[92:95], v215 offset:16384
    ds_read_b64_tr_b16 v[72:73], v208 offset:45056
    ds_read_b64_tr_b16 v[74:75], v208 offset:46080
    s_waitcnt lgkmcnt(10)
    v_mfma_f32_32x32x16_bf16 v[16:31], v[56:59], v[84:87], v[16:31]
    ds_read_b64_tr_b16 v[76:77], v209 offset:45056
    ds_read_b64_tr_b16 v[78:79], v209 offset:46080
    s_waitcnt lgkmcnt(10)
    v_mfma_f32_32x32x16_bf16 v[32:47], v[60:63], v[84:87], v[32:47]
    s_barrier
    ds_read_b128 v[80:83], v212 offset:24576
    ds_read_b64_tr_b16 v[48:49], v208 offset:49152
    ds_read_b64_tr_b16 v[50:51], v208 offset:50176
    s_waitcnt lgkmcnt(10)
    v_mfma_f32_32x32x16_bf16 v[16:31], v[64:67], v[88:91], v[16:31]
    ds_read_b64_tr_b16 v[52:53], v209 offset:49152
    ds_read_b64_tr_b16 v[54:55], v209 offset:50176
    s_waitcnt lgkmcnt(10)
    v_mfma_f32_32x32x16_bf16 v[32:47], v[68:71], v[88:91], v[32:47]
    ds_read_b128 v[84:87], v213 offset:24576
    ds_read_b64_tr_b16 v[56:57], v208 offset:53248
    ds_read_b64_tr_b16 v[58:59], v208 offset:54272
    s_waitcnt lgkmcnt(10)
    v_mfma_f32_32x32x16_bf16 v[16:31], v[72:75], v[92:95], v[16:31]
    ds_read_b64_tr_b16 v[60:61], v209 offset:53248
    ds_read_b64_tr_b16 v[62:63], v209 offset:54272
    s_waitcnt lgkmcnt(10)
    v_mfma_f32_32x32x16_bf16 v[32:47], v[76:79], v[92:95], v[32:47]
    ds_read_b128 v[88:91], v214 offset:24576
    ds_read_b64_tr_b16 v[64:65], v208 offset:57344
    ds_read_b64_tr_b16 v[66:67], v208 offset:58368
    s_waitcnt lgkmcnt(10)
    v_mfma_f32_32x32x16_bf16 v[16:31], v[48:51], v[80:83], v[16:31]
    ds_read_b64_tr_b16 v[68:69], v209 offset:57344
    ds_read_b64_tr_b16 v[70:71], v209 offset:58368
    s_waitcnt lgkmcnt(10)
    v_mfma_f32_32x32x16_bf16 v[32:47], v[52:55], v[80:83], v[32:47]
    ds_read_b128 v[92:95], v215 offset:24576
    ds_read_b64_tr_b16 v[72:73], v208 offset:61440
    ds_read_b64_tr_b16 v[74:75], v208 offset:62464
    s_waitcnt lgkmcnt(10)
    v_mfma_f32_32x32x16_bf16 v[16:31], v[56:59], v[84:87], v[16:31]
    s_waitcnt lgkmcnt(0)
    s_waitcnt lgkmcnt(0)
    s_mul_i32 s57, s57, 0x9E3779B1
    s_add_u32 s57, s57, 0x7F4A7C15
    s_and_b32 s68, s57, 0xfff
    s_bfe_u32 s69, s57, 0xc000c
    s_lshr_b32 s70, s57, 24
    s_or_b32 s70, s70, 0xa00
    s_mul_i32 s71, s57, 0x85EBCA6B
    s_lshr_b32 s71, s71, 20
    ds_read_b64_tr_b16 v[76:77], v209 offset:61440
    ds_read_b64_tr_b16 v[78:79], v209 offset:62464
    v_mfma_f32_32x32x16_bf16 v[32:47], v[60:63], v[84:87], v[32:47]
    s_barrier
    ds_read_b128 v[80:83], v212 offset:32768
    ds_read_b64_tr_b16 v[48:49], v210 offset:0
    ds_read_b64_tr_b16 v[50:51], v210 offset:1024
    v_mfma_f32_32x32x16_bf16 v[16:31], v[64:67], v[88:91], v[16:31]
    ds_read_b64_tr_b16 v[52:53], v211 offset:0
    ds_read_b64_tr_b16 v[54:55], v211 offset:1024
    v_mfma_f32_32x32x16_bf16 v[32:47], v[68:71], v[88:91], v[32:47]
    ds_read_b128 v[84:87], v213 offset:32768
    ds_read_b64_tr_b16 v[56:57], v210 offset:4096
    ds_read_b64_tr_b16 v[58:59], v210 offset:5120
    v_mfma_f32_32x32x16_bf16 v[16:31], v[72:75], v[92:95], v[16:31]
    ds_read_b64_tr_b16 v[60:61], v211 offset:4096
    ds_read_b64_tr_b16 v[62:63], v211 offset:5120
    s_waitcnt lgkmcnt(10)
    v_mfma_f32_32x32x16_bf16 v[32:47], v[76:79], v[92:95], v[32:47]
    ds_read_b128 v[88:91], v214 offset:32768
    ds_read_b64_tr_b16 v[64:65], v210 offset:8192
    ds_read_b64_tr_b16 v[66:67], v210 offset:9216
    s_waitcnt lgkmcnt(10)
    v_mfma_f32_32x32x16_bf16 v[16:31], v[48:51], v[80:83], v[16:31]
    ds_read_b64_tr_b16 v[68:69], v211 offset:8192
    ds_read_b64_tr_b16 v[70:71], v211 offset:9216
    s_waitcnt lgkmcnt(10)
    v_mfma_f32_32x32x16_bf16 v[32:47], v[52:55], v[80:83], v[32:47]
    ds_read_b128 v[92:95], v215 offset:32768
    ds_read_b64_tr_b16 v[72:73], v210 offset:12288
    ds_read_b64_tr_b16 v[74:75], v210 offset:13312
    s_waitcnt lgkmcnt(10)
    v_mfma_f32_32x32x16_bf16 v[16:31], v[56:59], v[84:87], v[16:31]
    ds_read_b64_tr_b16 v[76:77], v211 offset:12288
    ds_read_b64_tr_b16 v[78:79], v211 offset:13312
    s_waitcnt lgkmcnt(10)
    v_mfma_f32_32x32x16_bf16 v[32:47], v[60:63], v[84:87], v[32:47]
    s_barrier
    ds_read_b128 v[80:83], v212 offset:40960
    ds_read_b64_tr_b16 v[48:49], v210 offset:16384
    ds_read_b64_tr_b16 v[50:51], v210 offset:17408
    s_waitcnt lgkmcnt(10)
    v_mfma_f32_32x32x16_bf16 v[16:31], v[64:67], v[88:91], v[16:31]
    ds_read_b64_tr_b16 v[52:53], v211 offset:16384
    ds_read_b64_tr_b16 v[54:55], v211 offset:17408
    s_waitcnt lgkmcnt(10)
    v_mfma_f32_32x32x16_bf16 v[32:47], v[68:71], v[88:91], v[32:47]
    ds_read_b128 v[84:87], v213 offset:40960
    ds_read_b64_tr_b16 v[56:57], v210 offset:20480
    ds_read_b64_tr_b16 v[58:59], v210 offset:21504
    s_waitcnt lgkmcnt(10)
    v_mfma_f32_32x32x16_bf16 v[16:31], v[72:75], v[92:95], v[16:31]
    ds_read_b64_tr_b16 v[60:61], v211 offset:20480
    ds_read_b64_tr_b16 v[62:63], v211 offset:21504
    s_waitcnt lgkmcnt(10)
    v_mfma_f32_32x32x16_bf16 v[32:47], v[76:79], v[92:95], v[32:47]
    ds_read_b128 v[88:91], v214 offset:40960
    ds_read_b64_tr_b16 v[64:65], v210 offset:24576
    ds_read_b64_tr_b16 v[66:67], v210 offset:25600
    s_waitcnt lgkmcnt(10)
    v_mfma_f32_32x32x16_bf16 v[16:31], v[48:51], v[80:83], v[16:31]
    ds_read_b64_tr_b16 v[68:69], v211 offset:24576
    ds_read_b64_tr_b16 v[70:71], v211 offset:25600
    s_waitcnt lgkmcnt(10)
    v_mfma_f32_32x32x16_bf16 v[32:47], v[52:55], v[80:83], v[32:47]
    ds_read_b128 v[92:95], v215 offset:40960
    ds_read_b64_tr_b16 v[72:73], v210 offset:28672
    ds_read_b64_tr_b16 v[74:75], v210 offset:29696
    s_waitcnt lgkmcnt(10)
    v_mfma_f32_32x32x16_bf16 v[16:31], v[56:59], v[84:87], v[16:31]
    ds_read_b64_tr_b16 v[76:77], v211 offset:28672
    ds_read_b64_tr_b16 v[78:79], v211 offset:29696
    s_waitcnt lgkmcnt(10)
    v_mfma_f32_32x32x16_bf16 v[32:47], v[60:63], v[84:87], v[32:47]
    s_barrier
    ds_read_b128 v[80:83], v212 offset:0
    ds_read_b64_tr_b16 v[48:49], v208 offset:0
    ds_read_b64_tr_b16 v[50:51], v208 offset:1024
    s_waitcnt lgkmcnt(10)
    v_mfma_f32_32x32x16_bf16 v[16:31], v[64:67], v[88:91], v[16:31]
    ds_read_b128 v[96:99], v8
    ds_read_b64_tr_b16 v[52:53], v209 offset:0
    ds_read_b64_tr_b16 v[54:55], v209 offset:1024
    s_waitcnt lgkmcnt(11)
    v_mfma_f32_32x32x16_bf16 v[32:47], v[68:71], v[88:91], v[32:47]
    ds_read_b128 v[100:103], v9
    ds_read_b128 v[84:87], v213 offset:0
    ds_read_b64_tr_b16 v[56:57], v208 offset:4096
    s_waitcnt lgkmcnt(11)
    v_mfma_f32_32x32x16_bf16 v[16:31], v[72:75], v[92:95], v[16:31]
    ds_read_b64_tr_b16 v[58:59], v208 offset:5120
    ds_read_b128 v[104:107], v10
    ds_read_b64_tr_b16 v[60:61], v209 offset:4096
    s_waitcnt lgkmcnt(12)
    v_mfma_f32_32x32x16_bf16 v[32:47], v[76:79], v[92:95], v[32:47]
    ds_read_b64_tr_b16 v[62:63], v209 offset:5120
    ds_read_b128 v[108:111], v11
    s_waitcnt lgkmcnt(11)
    v_mfma_f32_32x32x16_bf16 v[16:31], v[48:51], v[80:83], v[16:31]
    ds_write_b64 v231, v[240:241]
    ds_write_b32 v238, v240
    ds_read_b128 v[88:91], v214 offset:0
    s_waitcnt lgkmcnt(11)
    v_mfma_f32_32x32x16_bf16 v[32:47], v[52:55], v[80:83], v[32:47]
    ds_read_b64_tr_b16 v[64:65], v208 offset:8192
    ds_read_b64_tr_b16 v[66:67], v208 offset:9216
    ds_read_b128 v[112:115], v12
    s_waitcnt lgkmcnt(10)
    v_mfma_f32_32x32x16_bf16 v[16:31], v[56:59], v[84:87], v[16:31]
    ds_read_b64_tr_b16 v[68:69], v209 offset:8192
    ds_read_b64_tr_b16 v[70:71], v209 offset:9216
    ds_read_b128 v[116:119], v13
    s_waitcnt lgkmcnt(10)
    v_mfma_f32_32x32x16_bf16 v[32:47], v[60:63], v[84:87], v[32:47]
    ds_read_b128 v[92:95], v215 offset:0
    ds_read_b64_tr_b16 v[72:73], v208 offset:12288
    ds_read_b64_tr_b16 v[74:75], v208 offset:13312
    s_waitcnt lgkmcnt(7)
    v_mfma_f32_32x32x16_bf16 v[16:31], v[64:67], v[88:91], v[16:31]
    ds_read_b128 v[120:123], v14
    ds_read_b64_tr_b16 v[76:77], v209 offset:12288
    ds_read_b64_tr_b16 v[78:79], v209 offset:13312
    s_waitcnt lgkmcnt(7)
    v_mfma_f32_32x32x16_bf16 v[32:47], v[68:71], v[88:91], v[32:47]
    ds_read_b128 v[124:127], v15
    s_barrier
    ds_read_b128 v[80:83], v212 offset:8192
    ds_read_b64_tr_b16 v[48:49], v208 offset:16384
    s_waitcnt lgkmcnt(6)
    v_mfma_f32_32x32x16_bf16 v[16:31], v[72:75], v[92:95], v[16:31]
    ds_read_b64_tr_b16 v[50:51], v208 offset:17408
    ds_read_b128 v[84:87], v213 offset:8192
    ds_read_b64_tr_b16 v[52:53], v208 offset:20480
    s_waitcnt lgkmcnt(6)
    v_mfma_f32_32x32x16_bf16 v[32:47], v[76:79], v[92:95], v[32:47]
    ds_read_b64_tr_b16 v[54:55], v208 offset:21504
    ds_read_b128 v[88:91], v214 offset:8192
    ds_read_b64_tr_b16 v[56:57], v208 offset:24576
    s_waitcnt lgkmcnt(5)
    v_mfma_f32_32x32x16_bf16 v[16:31], v[48:51], v[80:83], v[16:31]
    ds_read_b64_tr_b16 v[58:59], v208 offset:25600
    ds_read_b128 v[92:95], v215 offset:8192
    ds_read_b64_tr_b16 v[60:61], v208 offset:28672
    s_waitcnt lgkmcnt(5)
    v_mfma_f32_32x32x16_bf16 v[16:31], v[52:55], v[84:87], v[16:31]
    ds_read_b64_tr_b16 v[62:63], v208 offset:29696
    ds_read_b64_tr_b16 v[64:65], v209 offset:16384
    ds_read_b64_tr_b16 v[66:67], v209 offset:17408
    s_waitcnt lgkmcnt(5)
    v_mfma_f32_32x32x16_bf16 v[16:31], v[56:59], v[88:91], v[16:31]
    ds_read_b64_tr_b16 v[68:69], v209 offset:20480
    ds_read_b64_tr_b16 v[70:71], v209 offset:21504
    ds_read_b64_tr_b16 v[72:73], v209 offset:24576
    s_waitcnt lgkmcnt(5)
    v_mfma_f32_32x32x16_bf16 v[16:31], v[60:63], v[92:95], v[16:31]
    ds_read_b64_tr_b16 v[74:75], v209 offset:25600
    ds_read_b64_tr_b16 v[76:77], v209 offset:28672
    ds_read_b64_tr_b16 v[78:79], v209 offset:29696
    s_waitcnt lgkmcnt(6)
    v_mfma_f32_32x32x16_bf16 v[32:47], v[64:67], v[80:83], v[32:47]
    s_waitcnt lgkmcnt(4)
    v_mfma_f32_32x32x16_bf16 v[32:47], v[68:71], v[84:87], v[32:47]
    s_waitcnt lgkmcnt(2)
    v_mfma_f32_32x32x16_bf16 v[32:47], v[72:75], v[88:91], v[32:47]
    s_nop 2
    v_cvt_pk_bf16_f32 v128, v16, v17
    v_cvt_pk_bf16_f32 v129, v18, v19
    v_cvt_pk_bf16_f32 v130, v20, v21
    v_cvt_pk_bf16_f32 v131, v22, v23
    ds_write_b128 v229, v[128:131] offset:0
    s_waitcnt lgkmcnt(1)
    v_mfma_f32_32x32x16_bf16 v[32:47], v[76:79], v[92:95], v[32:47]
    v_cvt_pk_bf16_f32 v132, v24, v25
    v_cvt_pk_bf16_f32 v133, v26, v27
    v_cvt_pk_bf16_f32 v134, v28, v29
    v_cvt_pk_bf16_f32 v135, v30, v31
    ds_write_b128 v229, v[132:135] offset:1024
    v_mfma_f32_32x32x16_bf16 v[160:175], v[96:99], v[128:131], 0
    v_mfma_f32_32x32x16_bf16 v[160:175], v[100:103], v[132:135], v[160:175]
    s_nop 4
    v_cvt_pk_bf16_f32 v136, v32, v33
    v_cvt_pk_bf16_f32 v137, v34, v35
    v_cvt_pk_bf16_f32 v138, v36, v37
    v_cvt_pk_bf16_f32 v139, v38, v39
    ds_write_b128 v229, v[136:139] offset:2048
    v_cvt_pk_bf16_f32 v140, v40, v41
    v_cvt_pk_bf16_f32 v141, v42, v43
    v_cvt_pk_bf16_f32 v142, v44, v45
    v_cvt_pk_bf16_f32 v143, v46, v47
    ds_write_b128 v229, v[140:143] offset:3072
    ds_write_b32 v238, v242
    v_mfma_f32_32x32x16_bf16 v[160:175], v[104:107], v[136:139], v[160:175]
    v_mfma_f32_32x32x16_bf16 v[160:175], v[108:111], v[140:143], v[160:175]
    s_waitcnt lgkmcnt(0)
    s_mov_b32 s60, 524288
L_qpoll:
    ds_read_b32 v1, v239
    ds_read_b128 v[144:147], v230 offset:0
    ds_read_b128 v[148:151], v230 offset:1024
    ds_read_b128 v[152:155], v230 offset:2048
    ds_read_b128 v[156:159], v230 offset:3072
    s_sub_u32 s60, s60, 1
    s_waitcnt lgkmcnt(0)
    v_cmp_eq_u32 vcc, 0, v1
    s_cmp_eq_u32 s60, 0
    s_cbranch_scc1 L_qpoll_done
    s_cbranch_vccnz L_qpoll
L_qpoll_done:
    v_mfma_f32_32x32x16_bf16 v[160:175], v[112:115], v[144:147], v[160:175]
    v_mfma_f32_32x32x16_bf16 v[160:175], v[116:119], v[148:151], v[160:175]
    v_mfma_f32_32x32x16_bf16 v[160:175], v[120:123], v[152:155], v[160:175]
    v_mfma_f32_32x32x16_bf16 v[160:175], v[124:127], v[156:159], v[160:175]
    s_nop 11
    v_max3_f32 v1, v160, v161, v162
    v_max3_f32 v2, v163, v164, v165
    v_max3_f32 v3, v166, v167, v168
    v_max3_f32 v4, v169, v170, v171
    v_max3_f32 v5, v172, v173, v174
    v_max3_f32 v1, v1, v2, v175
    v_max3_f32 v3, v3, v4, v5
    v_max_f32 v1, v1, v3
    v_mov_b32 v2, v1
    s_nop 1
    v_permlane32_swap_b32 v1, v2
    v_max_f32 v1, v1, v2
    v_mul_f32 v2, s64, v1
    v_pk_fma_f32 v[160:161], v[160:161], s[64:65], v[2:3] op_sel_hi:[1,1,0] neg_lo:[0,0,1] neg_hi:[0,0,1]
    v_pk_fma_f32 v[162:163], v[162:163], s[64:65], v[2:3] op_sel_hi:[1,1,0] neg_lo:[0,0,1] neg_hi:[0,0,1]
    v_pk_fma_f32 v[164:165], v[164:165], s[64:65], v[2:3] op_sel_hi:[1,1,0] neg_lo:[0,0,1] neg_hi:[0,0,1]
    v_pk_fma_f32 v[166:167], v[166:167], s[64:65], v[2:3] op_sel_hi:[1,1,0] neg_lo:[0,0,1] neg_hi:[0,0,1]
    v_pk_fma_f32 v[168:169], v[168:169], s[64:65], v[2:3] op_sel_hi:[1,1,0] neg_lo:[0,0,1] neg_hi:[0,0,1]
    v_pk_fma_f32 v[170:171], v[170:171], s[64:65], v[2:3] op_sel_hi:[1,1,0] neg_lo:[0,0,1] neg_hi:[0,0,1]
    v_pk_fma_f32 v[172:173], v[172:173], s[64:65], v[2:3] op_sel_hi:[1,1,0] neg_lo:[0,0,1] neg_hi:[0,0,1]
    v_pk_fma_f32 v[174:175], v[174:175], s[64:65], v[2:3] op_sel_hi:[1,1,0] neg_lo:[0,0,1] neg_hi:[0,0,1]
    v_exp_f32 v160, v160
    v_exp_f32 v161, v161
    v_exp_f32 v162, v162
    v_exp_f32 v163, v163
    v_exp_f32 v164, v164
    v_exp_f32 v165, v165
    v_pk_add_f32 v[4:5], v[160:161], v[162:163]
    v_exp_f32 v166, v166
    v_exp_f32 v167, v167
    v_exp_f32 v168, v168
    v_exp_f32 v169, v169
    v_pk_add_f32 v[6:7], v[164:165], v[166:167]
    v_exp_f32 v170, v170
    v_exp_f32 v171, v171
    v_exp_f32 v172, v172
    v_exp_f32 v173, v173
    v_pk_add_f32 v[8:9], v[168:169], v[170:171]
    v_exp_f32 v174, v174
    v_exp_f32 v175, v175
    v_pk_add_f32 v[4:5], v[4:5], v[6:7]
    v_pk_add_f32 v[6:7], v[172:173], v[174:175]
    v_pk_add_f32 v[8:9], v[8:9], v[6:7]
    v_pk_add_f32 v[4:5], v[4:5], v[8:9]
    v_add_f32 v3, v4, v5
    v_mov_b32 v4, v3
    s_nop 1
    v_permlane32_swap_b32 v3, v4
    v_add_f32 v3, v3, v4
    ds_write_b64 v231, v[2:3]
    s_waitcnt lgkmcnt(0)
    s_mov_b32 s60, 524288
L_spoll:
    ds_read_b64 v[4:5], v232
    s_sub_u32 s60, s60, 1
    s_waitcnt lgkmcnt(0)
    v_cmp_eq_u32 vcc, 0, v5
    s_cmp_eq_u32 s60, 0
    s_cbranch_scc1 L_spoll_done
    s_cbranch_vccnz L_spoll
L_spoll_done:
    v_max_f32 v1, v2, v4
    v_sub_f32 v6, v2, v1
    v_sub_f32 v7, v4, v1
    v_exp_f32 v6, v6
    v_exp_f32 v7, v7
    v_mul_f32 v3, v3, v6
    v_fma_f32 v3, v5, v7, v3
    v_rcp_f32 v3, v3
    s_nop 0
    v_mul_f32 v8, v6, v3
    v_pk_mul_f32 v[160:161], v[160:161], v[8:9] op_sel_hi:[1,0]
    v_pk_mul_f32 v[162:163], v[162:163], v[8:9] op_sel_hi:[1,0]
    v_pk_mul_f32 v[164:165], v[164:165], v[8:9] op_sel_hi:[1,0]
    v_pk_mul_f32 v[166:167], v[166:167], v[8:9] op_sel_hi:[1,0]
    v_cvt_pk_bf16_f32 v144, v160, v161
    v_cvt_pk_bf16_f32 v145, v162, v163
    v_cvt_pk_bf16_f32 v146, v164, v165
    v_cvt_pk_bf16_f32 v147, v166, v167
    buffer_store_dwordx4 v[144:147], v228, s[44:47], s5 offen sc1
    v_pk_mul_f32 v[168:169], v[168:169], v[8:9] op_sel_hi:[1,0]
    v_pk_mul_f32 v[170:171], v[170:171], v[8:9] op_sel_hi:[1,0]
    v_pk_mul_f32 v[172:173], v[172:173], v[8:9] op_sel_hi:[1,0]
    v_pk_mul_f32 v[174:175], v[174:175], v[8:9] op_sel_hi:[1,0]
    v_cvt_pk_bf16_f32 v148, v168, v169
    v_cvt_pk_bf16_f32 v149, v170, v171
    v_cvt_pk_bf16_f32 v150, v172, v173
    v_cvt_pk_bf16_f32 v151, v174, v175
    buffer_store_dwordx4 v[148:151], v228, s[44:47], s5 offen offset:1024 sc1
    v_mov_b32 v243, s57
    s_mov_b32 s75, 0
    s_barrier
    ds_read_b128 v[176:179], v216
    ds_read_b128 v[180:183], v217
    ds_read_b128 v[184:187], v218
    ds_read_b128 v[188:191], v219
    ds_read_b128 v[192:195], v220
    ds_read_b128 v[196:199], v221
    ds_read_b128 v[200:203], v222
    ds_read_b128 v[204:207], v223
    ds_read_b64_tr_b16 v[48:49], v224 offset:49152
    ds_read_b64_tr_b16 v[50:51], v224 offset:49664
    ds_read_b64_tr_b16 v[52:53], v224 offset:51200
    ds_read_b64_tr_b16 v[54:55], v224 offset:51712
    ds_read_b64_tr_b16 v[56:57], v224 offset:53248
    ds_read_b64_tr_b16 v[58:59], v224 offset:53760
    s_waitcnt lgkmcnt(4)
    v_mfma_f32_32x32x16_bf16 v[16:31], v[176:179], v[48:51], 0
    ds_read_b64_tr_b16 v[60:61], v224 offset:55296
    ds_read_b64_tr_b16 v[62:63], v224 offset:55808
    ds_read_b64_tr_b16 v[64:65], v224 offset:57344
    s_waitcnt lgkmcnt(5)
    v_mfma_f32_32x32x16_bf16 v[16:31], v[180:183], v[52:55], v[16:31]
    ds_read_b64_tr_b16 v[66:67], v224 offset:57856
    ds_read_b64_tr_b16 v[68:69], v224 offset:59392
    ds_read_b64_tr_b16 v[70:71], v224 offset:59904
    s_waitcnt lgkmcnt(6)
    v_mfma_f32_32x32x16_bf16 v[16:31], v[184:187], v[56:59], v[16:31]
    ds_read_b64_tr_b16 v[72:73], v224 offset:61440
    ds_read_b64_tr_b16 v[74:75], v224 offset:61952
    s_waitcnt lgkmcnt(6)
    v_mfma_f32_32x32x16_bf16 v[16:31], v[188:191], v[60:63], v[16:31]
    ds_read_b64_tr_b16 v[76:77], v224 offset:63488
    ds_read_b64_tr_b16 v[78:79], v224 offset:64000
    s_waitcnt lgkmcnt(6)
    v_mfma_f32_32x32x16_bf16 v[16:31], v[192:195], v[64:67], v[16:31]
    s_waitcnt vmcnt(0)
    s_mov_b64 exec, 1
    buffer_store_dword v243, v240, s[44:47], s4 offen sc1
    s_mov_b64 exec, -1
    s_barrier
    ds_read_b64_tr_b16 v[48:49], v225 offset:0
    ds_read_b64_tr_b16 v[50:51], v225 offset:512
    s_waitcnt lgkmcnt(6)
    v_mfma_f32_32x32x16_bf16 v[16:31], v[196:199], v[68:71], v[16:31]
    ds_read_b64_tr_b16 v[52:53], v225 offset:2048
    ds_read_b64_tr_b16 v[54:55], v225 offset:2560
    s_waitcnt lgkmcnt(6)
    v_mfma_f32_32x32x16_bf16 v[16:31], v[200:203], v[72:75], v[16:31]
    ds_read_b64_tr_b16 v[56:57], v225 offset:4096
    ds_read_b64_tr_b16 v[58:59], v225 offset:4608
    s_waitcnt lgkmcnt(6)
    v_mfma_f32_32x32x16_bf16 v[16:31], v[204:207], v[76:79], v[16:31]
    ds_read_b64_tr_b16 v[60:61], v225 offset:6144
    ds_read_b64_tr_b16 v[62:63], v225 offset:6656
    s_waitcnt lgkmcnt(6)
    v_mfma_f32_32x32x16_bf16 v[32:47], v[176:179], v[48:51], 0
    v_add_u32 v216, 114688, v216
    ds_read_b64_tr_b16 v[64:65], v225 offset:8192
    ds_read_b64_tr_b16 v[66:67], v225 offset:8704
    s_waitcnt lgkmcnt(6)
    v_mfma_f32_32x32x16_bf16 v[32:47], v[180:183], v[52:55], v[32:47]
    s_nop 2
    v_cvt_pk_bf16_f32 v80, v16, v17
    v_add_u32 v217, 114688, v217
    ds_read_b64_tr_b16 v[68:69], v225 offset:10240
    ds_read_b64_tr_b16 v[70:71], v225 offset:10752
    s_waitcnt lgkmcnt(6)
    v_mfma_f32_32x32x16_bf16 v[32:47], v[184:187], v[56:59], v[32:47]
    v_cvt_pk_bf16_f32 v81, v18, v19
    v_add_u32 v218, 114688, v218
    ds_read_b64_tr_b16 v[72:73], v225 offset:12288
    ds_read_b64_tr_b16 v[74:75], v225 offset:12800
    s_waitcnt lgkmcnt(6)
    v_mfma_f32_32x32x16_bf16 v[32:47], v[188:191], v[60:63], v[32:47]
    v_cvt_pk_bf16_f32 v82, v20, v21
    v_add_u32 v219, 114688, v219
    ds_read_b64_tr_b16 v[76:77], v225 offset:14336
    ds_read_b64_tr_b16 v[78:79], v225 offset:14848
    s_waitcnt lgkmcnt(6)
    v_mfma_f32_32x32x16_bf16 v[32:47], v[192:195], v[64:67], v[32:47]
    v_cvt_pk_bf16_f32 v83, v22, v23
    v_add_u32 v220, 114688, v220
    s_barrier
    ds_read_b64_tr_b16 v[48:49], v225 offset:16384
    ds_read_b64_tr_b16 v[50:51], v225 offset:16896
    s_waitcnt lgkmcnt(6)
    v_mfma_f32_32x32x16_bf16 v[32:47], v[196:199], v[68:71], v[32:47]
    v_cvt_pk_bf16_f32 v84, v24, v25
    v_add_u32 v221, 114688, v221
    ds_read_b64_tr_b16 v[52:53], v225 offset:18432
    ds_read_b64_tr_b16 v[54:55], v225 offset:18944
    s_waitcnt lgkmcnt(6)
    v_mfma_f32_32x32x16_bf16 v[32:47], v[200:203], v[72:75], v[32:47]
    v_cvt_pk_bf16_f32 v85, v26, v27
    v_add_u32 v222, 114688, v222
    ds_read_b64_tr_b16 v[56:57], v225 offset:20480
    ds_read_b64_tr_b16 v[58:59], v225 offset:20992
    s_waitcnt lgkmcnt(6)
    v_mfma_f32_32x32x16_bf16 v[32:47], v[204:207], v[76:79], v[32:47]
    v_cvt_pk_bf16_f32 v86, v28, v29
    v_cvt_pk_bf16_f32 v87, v30, v31
    v_add_u32 v223, 114688, v223
    ds_read_b64_tr_b16 v[60:61], v225 offset:22528
    ds_read_b64_tr_b16 v[62:63], v225 offset:23040
    s_waitcnt lgkmcnt(6)
    v_mfma_f32_32x32x16_bf16 v[16:31], v[176:179], v[48:51], 0
    ds_read_b64_tr_b16 v[64:65], v225 offset:24576
    ds_read_b64_tr_b16 v[66:67], v225 offset:25088
    s_waitcnt lgkmcnt(6)
    v_mfma_f32_32x32x16_bf16 v[16:31], v[180:183], v[52:55], v[16:31]
    s_nop 0
    v_cvt_pk_bf16_f32 v88, v32, v33
    ds_read_b64_tr_b16 v[68:69], v225 offset:26624
    ds_read_b64_tr_b16 v[70:71], v225 offset:27136
    s_waitcnt lgkmcnt(6)
    v_mfma_f32_32x32x16_bf16 v[16:31], v[184:187], v[56:59], v[16:31]
    v_cvt_pk_bf16_f32 v89, v34, v35
    ds_read_b64_tr_b16 v[72:73], v225 offset:28672
    ds_read_b64_tr_b16 v[74:75], v225 offset:29184
    s_waitcnt lgkmcnt(6)
    v_mfma_f32_32x32x16_bf16 v[16:31], v[188:191], v[60:63], v[16:31]
    v_cvt_pk_bf16_f32 v90, v36, v37
    ds_read_b64_tr_b16 v[76:77], v225 offset:30720
    ds_read_b64_tr_b16 v[78:79], v225 offset:31232
    s_waitcnt lgkmcnt(6)
    v_mfma_f32_32x32x16_bf16 v[16:31], v[192:195], v[64:67], v[16:31]
    v_cvt_pk_bf16_f32 v91, v38, v39
    s_barrier
    ds_read_b64_tr_b16 v[48:49], v225 offset:49152
    ds_read_b64_tr_b16 v[50:51], v225 offset:49664
    s_waitcnt lgkmcnt(6)
    v_mfma_f32_32x32x16_bf16 v[16:31], v[196:199], v[68:71], v[16:31]
    v_cvt_pk_bf16_f32 v92, v40, v41
    ds_read_b64_tr_b16 v[52:53], v225 offset:51200
    ds_read_b64_tr_b16 v[54:55], v225 offset:51712
    s_waitcnt lgkmcnt(6)
    v_mfma_f32_32x32x16_bf16 v[16:31], v[200:203], v[72:75], v[16:31]
    v_cvt_pk_bf16_f32 v93, v42, v43
    ds_read_b64_tr_b16 v[56:57], v225 offset:53248
    ds_read_b64_tr_b16 v[58:59], v225 offset:53760
    s_waitcnt lgkmcnt(6)
    v_mfma_f32_32x32x16_bf16 v[16:31], v[204:207], v[76:79], v[16:31]
    v_cvt_pk_bf16_f32 v94, v44, v45
    v_cvt_pk_bf16_f32 v95, v46, v47
    ds_read_b64_tr_b16 v[60:61], v225 offset:55296
    ds_read_b64_tr_b16 v[62:63], v225 offset:55808
    s_waitcnt lgkmcnt(6)
    v_mfma_f32_32x32x16_bf16 v[32:47], v[176:179], v[48:51], 0
    ds_read_b64_tr_b16 v[64:65], v225 offset:57344
    ds_read_b64_tr_b16 v[66:67], v225 offset:57856
    s_waitcnt lgkmcnt(6)
    v_mfma_f32_32x32x16_bf16 v[32:47], v[180:183], v[52:55], v[32:47]
    s_nop 1
    v_cvt_pk_bf16_f32 v96, v16, v17
    ds_read_b64_tr_b16 v[68:69], v225 offset:59392
    ds_read_b64_tr_b16 v[70:71], v225 offset:59904
    s_waitcnt lgkmcnt(6)
    v_mfma_f32_32x32x16_bf16 v[32:47], v[184:187], v[56:59], v[32:47]
    v_cvt_pk_bf16_f32 v97, v18, v19
    ds_read_b64_tr_b16 v[72:73], v225 offset:61440
    ds_read_b64_tr_b16 v[74:75], v225 offset:61952
    s_waitcnt lgkmcnt(6)
    v_mfma_f32_32x32x16_bf16 v[32:47], v[188:191], v[60:63], v[32:47]
    v_cvt_pk_bf16_f32 v98, v20, v21
    ds_read_b64_tr_b16 v[76:77], v225 offset:63488
    ds_read_b64_tr_b16 v[78:79], v225 offset:64000
    s_waitcnt lgkmcnt(6)
    v_mfma_f32_32x32x16_bf16 v[32:47], v[192:195], v[64:67], v[32:47]
    v_cvt_pk_bf16_f32 v99, v22, v23
    s_barrier
    ds_read_b128 v[176:179], v216
    ds_read_b64_tr_b16 v[48:49], v226 offset:0
    ds_read_b64_tr_b16 v[50:51], v226 offset:512
    s_waitcnt lgkmcnt(7)
    v_mfma_f32_32x32x16_bf16 v[32:47], v[196:199], v[68:71], v[32:47]
    v_cvt_pk_bf16_f32 v100, v24, v25
    ds_read_b128 v[180:183], v217
    ds_read_b64_tr_b16 v[52:53], v226 offset:2048
    ds_read_b64_tr_b16 v[54:55], v226 offset:2560
    s_waitcnt lgkmcnt(8)
    v_mfma_f32_32x32x16_bf16 v[32:47], v[200:203], v[72:75], v[32:47]
    v_cvt_pk_bf16_f32 v101, v26, v27
    ds_read_b128 v[184:187], v218
    ds_read_b64_tr_b16 v[56:57], v226 offset:4096
    ds_read_b64_tr_b16 v[58:59], v226 offset:4608
    s_waitcnt lgkmcnt(9)
    v_mfma_f32_32x32x16_bf16 v[32:47], v[204:207], v[76:79], v[32:47]
    v_cvt_pk_bf16_f32 v102, v28, v29
    v_cvt_pk_bf16_f32 v103, v30, v31
    ds_read_b128 v[188:191], v219
    ds_read_b64_tr_b16 v[60:61], v226 offset:6144
    ds_read_b64_tr_b16 v[62:63], v226 offset:6656
    s_waitcnt lgkmcnt(9)
    v_mfma_f32_32x32x16_bf16 v[16:31], v[176:179], v[48:51], 0
    ds_read_b128 v[192:195], v220
    ds_read_b64_tr_b16 v[64:65], v226 offset:8192
    ds_read_b64_tr_b16 v[66:67], v226 offset:8704
    s_waitcnt lgkmcnt(9)
    v_mfma_f32_32x32x16_bf16 v[16:31], v[180:183], v[52:55], v[16:31]
    v_cvt_pk_bf16_f32 v104, v32, v33
    ds_read_b128 v[196:199], v221
    ds_read_b64_tr_b16 v[68:69], v226 offset:10240
    ds_read_b64_tr_b16 v[70:71], v226 offset:10752
    s_waitcnt lgkmcnt(9)
    v_mfma_f32_32x32x16_bf16 v[16:31], v[184:187], v[56:59], v[16:31]
    v_cvt_pk_bf16_f32 v105, v34, v35
    ds_read_b128 v[200:203], v222
    ds_read_b64_tr_b16 v[72:73], v226 offset:12288
    ds_read_b64_tr_b16 v[74:75], v226 offset:12800
    s_waitcnt lgkmcnt(9)
    v_mfma_f32_32x32x16_bf16 v[16:31], v[188:191], v[60:63], v[16:31]
    v_cvt_pk_bf16_f32 v106, v36, v37
    ds_read_b128 v[204:207], v223
    ds_read_b64_tr_b16 v[76:77], v226 offset:14336
    ds_read_b64_tr_b16 v[78:79], v226 offset:14848
    s_waitcnt lgkmcnt(9)
    v_mfma_f32_32x32x16_bf16 v[16:31], v[192:195], v[64:67], v[16:31]
    v_cvt_pk_bf16_f32 v107, v38, v39
    s_barrier
    ds_read_b64_tr_b16 v[48:49], v224 offset:0
    ds_read_b64_tr_b16 v[50:51], v224 offset:512
    s_waitcnt lgkmcnt(8)
    v_mfma_f32_32x32x16_bf16 v[16:31], v[196:199], v[68:71], v[16:31]
    v_cvt_pk_bf16_f32 v108, v40, v41
    ds_read_b64_tr_b16 v[52:53], v224 offset:2048
    ds_read_b64_tr_b16 v[54:55], v224 offset:2560
    s_waitcnt lgkmcnt(7)
    v_mfma_f32_32x32x16_bf16 v[16:31], v[200:203], v[72:75], v[16:31]
    v_cvt_pk_bf16_f32 v109, v42, v43
    ds_read_b64_tr_b16 v[56:57], v224 offset:4096
    ds_read_b64_tr_b16 v[58:59], v224 offset:4608
    s_waitcnt lgkmcnt(6)
    v_mfma_f32_32x32x16_bf16 v[16:31], v[204:207], v[76:79], v[16:31]
    v_cvt_pk_bf16_f32 v110, v44, v45
    v_cvt_pk_bf16_f32 v111, v46, v47
    ds_read_b64_tr_b16 v[60:61], v224 offset:6144
    ds_read_b64_tr_b16 v[62:63], v224 offset:6656
    s_waitcnt lgkmcnt(6)
    v_mfma_f32_32x32x16_bf16 v[32:47], v[176:179], v[48:51], 0
    ds_read_b64_tr_b16 v[64:65], v224 offset:8192
    ds_read_b64_tr_b16 v[66:67], v224 offset:8704
    s_waitcnt lgkmcnt(6)
    v_mfma_f32_32x32x16_bf16 v[32:47], v[180:183], v[52:55], v[32:47]
    s_nop 1
    v_cvt_pk_bf16_f32 v112, v16, v17
    ds_read_b64_tr_b16 v[68:69], v224 offset:10240
    ds_read_b64_tr_b16 v[70:71], v224 offset:10752
    s_waitcnt lgkmcnt(6)
    v_mfma_f32_32x32x16_bf16 v[32:47], v[184:187], v[56:59], v[32:47]
    v_cvt_pk_bf16_f32 v113, v18, v19
    ds_read_b64_tr_b16 v[72:73], v224 offset:12288
    ds_read_b64_tr_b16 v[74:75], v224 offset:12800
    s_waitcnt lgkmcnt(6)
    v_mfma_f32_32x32x16_bf16 v[32:47], v[188:191], v[60:63], v[32:47]
    v_cvt_pk_bf16_f32 v114, v20, v21
    ds_read_b64_tr_b16 v[76:77], v224 offset:14336
    ds_read_b64_tr_b16 v[78:79], v224 offset:14848
    s_waitcnt lgkmcnt(6)
    v_mfma_f32_32x32x16_bf16 v[32:47], v[192:195], v[64:67], v[32:47]
    v_cvt_pk_bf16_f32 v115, v22, v23
    s_barrier
    ds_read_b64_tr_b16 v[48:49], v224 offset:16384
    ds_read_b64_tr_b16 v[50:51], v224 offset:16896
    s_waitcnt lgkmcnt(6)
    v_mfma_f32_32x32x16_bf16 v[32:47], v[196:199], v[68:71], v[32:47]
    v_cvt_pk_bf16_f32 v116, v24, v25
    ds_read_b64_tr_b16 v[52:53], v224 offset:18432
    ds_read_b64_tr_b16 v[54:55], v224 offset:18944
    s_waitcnt lgkmcnt(6)
    v_mfma_f32_32x32x16_bf16 v[32:47], v[200:203], v[72:75], v[32:47]
    v_cvt_pk_bf16_f32 v117, v26, v27
    ds_read_b64_tr_b16 v[56:57], v224 offset:20480
    ds_read_b64_tr_b16 v[58:59], v224 offset:20992
    s_waitcnt lgkmcnt(6)
    v_mfma_f32_32x32x16_bf16 v[32:47], v[204:207], v[76:79], v[32:47]
    v_cvt_pk_bf16_f32 v118, v28, v29
    v_cvt_pk_bf16_f32 v119, v30, v31
    ds_read_b64_tr_b16 v[60:61], v224 offset:22528
    ds_read_b64_tr_b16 v[62:63], v224 offset:23040
    s_waitcnt lgkmcnt(6)
    v_mfma_f32_32x32x16_bf16 v[16:31], v[176:179], v[48:51], 0
    ds_read_b64_tr_b16 v[64:65], v224 offset:24576
    ds_read_b64_tr_b16 v[66:67], v224 offset:25088
    s_waitcnt lgkmcnt(6)
    v_mfma_f32_32x32x16_bf16 v[16:31], v[180:183], v[52:55], v[16:31]
    s_nop 1
    v_cvt_pk_bf16_f32 v120, v32, v33
    ds_read_b64_tr_b16 v[68:69], v224 offset:26624
    ds_read_b64_tr_b16 v[70:71], v224 offset:27136
    s_waitcnt lgkmcnt(6)
    v_mfma_f32_32x32x16_bf16 v[16:31], v[184:187], v[56:59], v[16:31]
    v_cvt_pk_bf16_f32 v121, v34, v35
    ds_read_b64_tr_b16 v[72:73], v224 offset:28672
    ds_read_b64_tr_b16 v[74:75], v224 offset:29184
    s_waitcnt lgkmcnt(6)
    v_mfma_f32_32x32x16_bf16 v[16:31], v[188:191], v[60:63], v[16:31]
    v_cvt_pk_bf16_f32 v122, v36, v37
    ds_read_b64_tr_b16 v[76:77], v224 offset:30720
    ds_read_b64_tr_b16 v[78:79], v224 offset:31232
    s_waitcnt lgkmcnt(6)
    v_mfma_f32_32x32x16_bf16 v[16:31], v[192:195], v[64:67], v[16:31]
    v_cvt_pk_bf16_f32 v123, v38, v39
    ds_read_b64_tr_b16 v[48:49], v225 offset:32768
    ds_read_b64_tr_b16 v[50:51], v225 offset:33280
    s_waitcnt lgkmcnt(6)
    v_mfma_f32_32x32x16_bf16 v[16:31], v[196:199], v[68:71], v[16:31]
    v_cvt_pk_bf16_f32 v124, v40, v41
    ds_read_b64_tr_b16 v[52:53], v225 offset:34816
    ds_read_b64_tr_b16 v[54:55], v225 offset:35328
    s_waitcnt lgkmcnt(6)
    v_mfma_f32_32x32x16_bf16 v[16:31], v[200:203], v[72:75], v[16:31]
    v_cvt_pk_bf16_f32 v125, v42, v43
    ds_read_b64_tr_b16 v[56:57], v225 offset:36864
    ds_read_b64_tr_b16 v[58:59], v225 offset:37376
    s_waitcnt lgkmcnt(6)
    v_mfma_f32_32x32x16_bf16 v[16:31], v[204:207], v[76:79], v[16:31]
    v_cvt_pk_bf16_f32 v126, v44, v45
    v_cvt_pk_bf16_f32 v127, v46, v47
    ds_read_b64_tr_b16 v[60:61], v225 offset:38912
    ds_read_b64_tr_b16 v[62:63], v225 offset:39424
    s_waitcnt lgkmcnt(6)
    v_mfma_f32_32x32x16_bf16 v[32:47], v[176:179], v[48:51], 0
    ds_read_b64_tr_b16 v[64:65], v225 offset:40960
    ds_read_b64_tr_b16 v[66:67], v225 offset:41472
    s_waitcnt lgkmcnt(6)
    v_mfma_f32_32x32x16_bf16 v[32:47], v[180:183], v[52:55], v[32:47]
    s_nop 1
    v_cvt_pk_bf16_f32 v128, v16, v17
    ds_read_b64_tr_b16 v[68:69], v225 offset:43008
    ds_read_b64_tr_b16 v[70:71], v225 offset:43520
    s_waitcnt lgkmcnt(6)
    v_mfma_f32_32x32x16_bf16 v[32:47], v[184:187], v[56:59], v[32:47]
    v_cvt_pk_bf16_f32 v129, v18, v19
    ds_read_b64_tr_b16 v[72:73], v225 offset:45056
    ds_read_b64_tr_b16 v[74:75], v225 offset:45568
    s_waitcnt lgkmcnt(6)
    v_mfma_f32_32x32x16_bf16 v[32:47], v[188:191], v[60:63], v[32:47]
    v_cvt_pk_bf16_f32 v130, v20, v21
    ds_read_b64_tr_b16 v[76:77], v225 offset:47104
    ds_read_b64_tr_b16 v[78:79], v225 offset:47616
    s_waitcnt lgkmcnt(6)
    v_mfma_f32_32x32x16_bf16 v[32:47], v[192:195], v[64:67], v[32:47]
    v_cvt_pk_bf16_f32 v131, v22, v23
    s_barrier
    ds_read_b128 v[48:51], v236 offset:0
    s_waitcnt lgkmcnt(5)
    v_mfma_f32_32x32x16_bf16 v[32:47], v[196:199], v[68:71], v[32:47]
    v_cvt_pk_bf16_f32 v132, v24, v25
    ds_read_b128 v[52:55], v237 offset:0
    s_waitcnt lgkmcnt(4)
    v_mfma_f32_32x32x16_bf16 v[32:47], v[200:203], v[72:75], v[32:47]
    v_cvt_pk_bf16_f32 v133, v26, v27
    ds_read_b128 v[56:59], v236 offset:1024
    ds_read_b128 v[60:63], v237 offset:1024
    s_waitcnt lgkmcnt(4)
    v_mfma_f32_32x32x16_bf16 v[32:47], v[204:207], v[76:79], v[32:47]
    v_cvt_pk_bf16_f32 v134, v28, v29
    v_cvt_pk_bf16_f32 v135, v30, v31
    s_barrier
    ds_read_b128 v[64:67], v236 offset:8192
    s_waitcnt lgkmcnt(4)
    v_mfma_f32_32x32x16_bf16 v[160:175], v[80:83], v[48:51], 0
    ds_read_b128 v[68:71], v237 offset:8192
    s_waitcnt lgkmcnt(4)
    v_mfma_f32_32x32x16_bf16 v[176:191], v[80:83], v[52:55], 0
    s_nop 2
    v_cvt_pk_bf16_f32 v136, v32, v33
    v_cvt_pk_bf16_f32 v137, v34, v35
    ds_read_b128 v[72:75], v236 offset:9216
    s_waitcnt lgkmcnt(4)
    v_mfma_f32_32x32x16_bf16 v[160:175], v[84:87], v[56:59], v[160:175]
    v_cvt_pk_bf16_f32 v138, v36, v37
    v_cvt_pk_bf16_f32 v139, v38, v39
    ds_read_b128 v[76:79], v237 offset:9216
    s_waitcnt lgkmcnt(4)
    v_mfma_f32_32x32x16_bf16 v[176:191], v[84:87], v[60:63], v[176:191]
    v_cvt_pk_bf16_f32 v140, v40, v41
    v_cvt_pk_bf16_f32 v141, v42, v43
    s_barrier
    ds_read_b128 v[48:51], v236 offset:16384
    s_waitcnt lgkmcnt(4)
    v_mfma_f32_32x32x16_bf16 v[160:175], v[88:91], v[64:67], v[160:175]
    v_cvt_pk_bf16_f32 v142, v44, v45
    v_cvt_pk_bf16_f32 v143, v46, v47
    ds_read_b128 v[52:55], v237 offset:16384
    s_waitcnt lgkmcnt(4)
    v_mfma_f32_32x32x16_bf16 v[176:191], v[88:91], v[68:71], v[176:191]
    ds_read_b128 v[56:59], v236 offset:17408
    s_waitcnt lgkmcnt(4)
    v_mfma_f32_32x32x16_bf16 v[160:175], v[92:95], v[72:75], v[160:175]
    ds_read_b128 v[60:63], v237 offset:17408
    s_waitcnt lgkmcnt(4)
    v_mfma_f32_32x32x16_bf16 v[176:191], v[92:95], v[76:79], v[176:191]
    s_barrier
    ds_read_b128 v[64:67], v236 offset:24576
    s_waitcnt lgkmcnt(4)
    v_mfma_f32_32x32x16_bf16 v[160:175], v[96:99], v[48:51], v[160:175]
    ds_read_b128 v[68:71], v237 offset:24576
    s_waitcnt lgkmcnt(4)
    v_mfma_f32_32x32x16_bf16 v[176:191], v[96:99], v[52:55], v[176:191]
    ds_read_b128 v[72:75], v236 offset:25600
    s_waitcnt lgkmcnt(4)
    v_mfma_f32_32x32x16_bf16 v[160:175], v[100:103], v[56:59], v[160:175]
    ds_read_b128 v[76:79], v237 offset:25600
    s_waitcnt lgkmcnt(4)
    v_mfma_f32_32x32x16_bf16 v[176:191], v[100:103], v[60:63], v[176:191]
    s_barrier
    ds_read_b128 v[48:51], v236 offset:32768
    s_waitcnt lgkmcnt(4)
    v_mfma_f32_32x32x16_bf16 v[160:175], v[104:107], v[64:67], v[160:175]
    ds_read_b128 v[52:55], v237 offset:32768
    s_waitcnt lgkmcnt(4)
    v_mfma_f32_32x32x16_bf16 v[176:191], v[104:107], v[68:71], v[176:191]
    ds_read_b128 v[56:59], v236 offset:33792
    s_waitcnt lgkmcnt(4)
    v_mfma_f32_32x32x16_bf16 v[160:175], v[108:111], v[72:75], v[160:175]
    ds_read_b128 v[60:63], v237 offset:33792
    s_waitcnt lgkmcnt(4)
    v_mfma_f32_32x32x16_bf16 v[176:191], v[108:111], v[76:79], v[176:191]
    s_barrier
    ds_read_b128 v[64:67], v236 offset:40960
    s_waitcnt lgkmcnt(4)
    v_mfma_f32_32x32x16_bf16 v[160:175], v[112:115], v[48:51], v[160:175]
    ds_read_b128 v[68:71], v237 offset:40960
    s_waitcnt lgkmcnt(4)
    v_mfma_f32_32x32x16_bf16 v[176:191], v[112:115], v[52:55], v[176:191]
    ds_read_b128 v[72:75], v236 offset:41984
    s_waitcnt lgkmcnt(4)
    v_mfma_f32_32x32x16_bf16 v[160:175], v[116:119], v[56:59], v[160:175]
    ds_read_b128 v[76:79], v237 offset:41984
    s_waitcnt lgkmcnt(4)
    v_mfma_f32_32x32x16_bf16 v[176:191], v[116:119], v[60:63], v[176:191]
    s_barrier
    ds_read_b128 v[48:51], v237 offset:49152
    s_waitcnt lgkmcnt(4)
    v_mfma_f32_32x32x16_bf16 v[160:175], v[120:123], v[64:67], v[160:175]
    ds_read_b128 v[52:55], v237 offset:50176
    s_waitcnt lgkmcnt(4)
    v_mfma_f32_32x32x16_bf16 v[176:191], v[120:123], v[68:71], v[176:191]
    s_barrier
    ds_read_b128 v[56:59], v237 offset:57344
    s_waitcnt lgkmcnt(4)
    v_mfma_f32_32x32x16_bf16 v[160:175], v[124:127], v[72:75], v[160:175]
    ds_read_b128 v[60:63], v237 offset:58368
    s_waitcnt lgkmcnt(4)
    v_mfma_f32_32x32x16_bf16 v[176:191], v[124:127], v[76:79], v[176:191]
    ds_read_b128 v[64:67], v236 offset:49152
    s_waitcnt lgkmcnt(4)
    v_mfma_f32_32x32x16_bf16 v[176:191], v[128:131], v[48:51], v[176:191]
    ds_read_b128 v[68:71], v236 offset:50176
    s_waitcnt lgkmcnt(4)
    v_mfma_f32_32x32x16_bf16 v[176:191], v[132:135], v[52:55], v[176:191]
    ds_read_b128 v[72:75], v236 offset:57344
    s_waitcnt lgkmcnt(4)
    v_mfma_f32_32x32x16_bf16 v[176:191], v[136:139], v[56:59], v[176:191]
    ds_read_b128 v[76:79], v236 offset:58368
    s_waitcnt lgkmcnt(4)
    v_mfma_f32_32x32x16_bf16 v[176:191], v[140:143], v[60:63], v[176:191]
    s_waitcnt lgkmcnt(3)
    v_mfma_f32_32x32x16_bf16 v[160:175], v[128:131], v[64:67], v[160:175]
    s_waitcnt lgkmcnt(2)
    v_mfma_f32_32x32x16_bf16 v[160:175], v[132:135], v[68:71], v[160:175]
    s_waitcnt lgkmcnt(1)
    v_mfma_f32_32x32x16_bf16 v[160:175], v[136:139], v[72:75], v[160:175]
    s_nop 5
    ds_write_b128 v233, v[176:179] offset:0
    ds_write_b128 v233, v[180:183] offset:1024
    s_waitcnt lgkmcnt(2)
    v_mfma_f32_32x32x16_bf16 v[160:175], v[140:143], v[76:79], v[160:175]
    ds_write_b128 v233, v[184:187] offset:2048
    ds_write_b128 v233, v[188:191] offset:3072
    s_waitcnt lgkmcnt(0)
    s_barrier
    ds_read_b128 v[48:51], v234 offset:0
    ds_read_b128 v[52:55], v234 offset:1024
    ds_read_b128 v[56:59], v234 offset:2048
    ds_read_b128 v[60:63], v234 offset:3072
    v_mov_b32 v15, 0xfff
    s_waitcnt lgkmcnt(3)
    s_nop 1
    v_pk_add_f32 v[160:161], v[160:161], v[48:49]
    v_pk_add_f32 v[162:163], v[162:163], v[50:51]
    v_bfi_b32 v64, v15, s68, v160
    v_bfi_b32 v65, v15, s69, v161
    v_bfi_b32 v66, v15, s70, v162
    v_bfi_b32 v67, v15, s71, v163
    buffer_store_dwordx4 v[64:67], v244, s[44:47], s72 offen offset:0 sc1
    s_waitcnt lgkmcnt(2)
    v_pk_add_f32 v[164:165], v[164:165], v[52:53]
    v_pk_add_f32 v[166:167], v[166:167], v[54:55]
    v_bfi_b32 v68, v15, s68, v164
    v_bfi_b32 v69, v15, s69, v165
    v_bfi_b32 v70, v15, s70, v166
    v_bfi_b32 v71, v15, s71, v167
    buffer_store_dwordx4 v[68:71], v244, s[44:47], s72 offen offset:512 sc1
    s_waitcnt lgkmcnt(1)
    v_pk_add_f32 v[168:169], v[168:169], v[56:57]
    v_pk_add_f32 v[170:171], v[170:171], v[58:59]
    v_bfi_b32 v72, v15, s68, v168
    v_bfi_b32 v73, v15, s69, v169
    v_bfi_b32 v74, v15, s70, v170
    v_bfi_b32 v75, v15, s71, v171
    buffer_store_dwordx4 v[72:75], v244, s[44:47], s72 offen offset:1024 sc1
    s_waitcnt lgkmcnt(0)
    v_pk_add_f32 v[172:173], v[172:173], v[60:61]
    v_pk_add_f32 v[174:175], v[174:175], v[62:63]
    v_bfi_b32 v76, v15, s68, v172
    v_bfi_b32 v77, v15, s69, v173
    v_bfi_b32 v78, v15, s70, v174
    v_bfi_b32 v79, v15, s71, v175
    buffer_store_dwordx4 v[76:79], v244, s[44:47], s72 offen offset:1536 sc1
    s_and_b64 exec, s[18:19], exec
    s_cbranch_execz L_noloc
    ds_write_b128 v235, v[160:163] offset:0
    ds_write_b128 v235, v[164:167] offset:512
    ds_write_b128 v235, v[168:171] offset:1024
    ds_write_b128 v235, v[172:175] offset:1536
L_noloc:
    s_mov_b64 exec, -1
    s_waitcnt lgkmcnt(0)
    s_barrier
    s_endpgm
L_end:
    s_endpgm
.section .rodata,"a"
.p2align 6
.amdhsa_kernel standalone__gqa_block_cached__near_ridge_kernel
  .amdhsa_next_free_vgpr 256
  .amdhsa_next_free_sgpr 102
  .amdhsa_accum_offset 256
  .amdhsa_group_segment_fixed_size 0
  .amdhsa_kernarg_size 64
  .amdhsa_user_sgpr_count 2
  .amdhsa_user_sgpr_kernarg_segment_ptr 1
  .amdhsa_system_sgpr_workgroup_id_x 1
.end_amdhsa_kernel
```
